```python
import torch

def _softmax(x, axis=-1):
    return torch.softmax(x, dim=axis)
def _gelu(x):
    return torch.nn.functional.gelu(x, approximate="tanh")
def _silu(x):
    return torch.nn.functional.silu(x)
def _sigmoid(x):
    return torch.sigmoid(x)
def _layernorm(x, axis=-1, eps=1e-5):
    m = x.mean(dim=axis, keepdim=True)
    v = x.var(dim=axis, keepdim=True, unbiased=False)
    return (x - m) / torch.sqrt(v + eps)
def _scatter_add(tgt, idx, src, axis=0):
    return tgt.clone().index_add_(axis, idx, src)
def _segment_sum(src, seg, n):
    out = torch.zeros((n,) + src.shape[1:], dtype=src.dtype)
    return out.index_add_(0, seg, src)
def _pad(x, pw):
    flat = tuple(v for pair in reversed(pw) for v in pair)
    return torch.nn.functional.pad(x, flat)

kernel_name = 'parallel_sum__gqa_block_cached__dense_activation_silu__decode'

def setup_inputs():

    _w = (lambda a: (lambda t: t.to(torch.bfloat16) if t.is_floating_point() else t)(torch.as_tensor(a)))
    def _A_setup():
        B, Sq, D = 2, 1, 1024
        Hq, Hkv, Sk, Dh = 32, 4, 32768, 128
        assert Hq % Hkv == 0, (Hq, Hkv)
        return {
            "x": _w((lambda *s: torch.randn(*s, dtype=torch.bfloat16) * 0.05)(B, Sq, D)),
            "k_cache": _w((lambda *s: torch.randn(*s, dtype=torch.bfloat16) * 3.2)(B, Hkv, Sk, Dh)),
            "v_cache": _w((lambda *s: torch.randn(*s, dtype=torch.bfloat16) * 0.8)(B, Hkv, Sk, Dh)),
            "wq": _w((lambda *s: torch.randn(*s, dtype=torch.bfloat16) * 3.2)(D, Hq * Dh) * (D ** -0.5)),
            "wo": _w((lambda *s: torch.randn(*s, dtype=torch.bfloat16) * 0.8)(Hq * Dh, D) * ((Hq * Dh) ** -0.5)),
        }
    _A_in = _A_setup()

    def _B_setup():
        B, S, D, F = 2, 1, 1024, 3584
        return {
            "x": _w((lambda *s: torch.randn(*s, dtype=torch.bfloat16) * 0.05)(B, S, D)),
            "w1": _w((lambda *s: torch.randn(*s, dtype=torch.bfloat16) * 3.2)(D, F) * (D ** -0.5)),
            "w2": _w((lambda *s: torch.randn(*s, dtype=torch.bfloat16) * 0.4)(F, D) * (F ** -0.5)),
        }
    _B_in = _B_setup()

    return {
        "A_x": _A_in["x"],
        "A_k_cache": _A_in["k_cache"],
        "A_v_cache": _A_in["v_cache"],
        "A_wq": _A_in["wq"],
        "A_wo": _A_in["wo"],
        "B_x": _B_in["x"],
        "B_w1": _B_in["w1"],
        "B_w2": _B_in["w2"],
    }

def reference(A_x, A_k_cache, A_v_cache, A_wq, A_wo, B_x, B_w1, B_w2):
    def _A_ref(x, k_cache, v_cache, wq, wo):
        B, Sq, D = x.shape
        Hq, Dh = 32, 128
        Hkv = k_cache.shape[1]
        rep = Hq // Hkv
        q = (lambda x, *d: x.permute(*d))((x @ wq).reshape(B, Sq, Hq, Dh), 0, 2, 1, 3)
        k = (lambda x, n, axis: torch.repeat_interleave(x, n, dim=axis))(k_cache, rep, axis=1)
        v = (lambda x, n, axis: torch.repeat_interleave(x, n, dim=axis))(v_cache, rep, axis=1)
        scores = torch.einsum("bhqd,bhkd->bhqk", q, k) * (Dh ** -0.5)
        p = _softmax(scores, axis=-1)
        o = torch.einsum("bhqk,bhkd->bhqd", p, v)
        return (lambda x, *d: x.permute(*d))(o, 0, 2, 1, 3).reshape(B, Sq, Hq * Dh) @ wo

    def _B_ref(x, w1, w2):
        h = torch.einsum("bsd,df->bsf", x, w1)
        h = _silu(h)
        out = torch.einsum("bsf,fd->bsd", h, w2)
        return out

    x = A_x
    xn = _layernorm(x, axis=-1)
    return x + _A_ref(xn, A_k_cache, A_v_cache, A_wq, A_wo) + _B_ref(xn, B_w1, B_w2)
```

```asm
; @launch grid=(256,1,1) block=(768,1,1) lds=147456
.amdgcn_target "amdgcn-amd-amdhsa--gfx950"
.text
.globl parallel_sum__gqa_block_cached__dense_activation_silu__decode_kernel
.p2align 8
.type parallel_sum__gqa_block_cached__dense_activation_silu__decode_kernel,@function
parallel_sum__gqa_block_cached__dense_activation_silu__decode_kernel:
    s_cmp_ge_u32 s2, 256
    s_cbranch_scc1 L_end
    s_load_dwordx16 s[4:19], s[0:1], 0
    s_load_dwordx4 s[20:23], s[0:1], 64
    s_load_dwordx2 s[24:25], s[0:1], 80
    v_lshrrev_b32 v16, 6, v0
    v_and_b32 v1, 63, v0
    v_readfirstlane_b32 s3, v16
    s_and_b32 s56, s2, 7
    s_lshr_b32 s57, s2, 3
    s_bfe_u32 s91, s2, 0x50002
    s_and_b32 s59, s57, 1
    s_xor_b32 s91, s91, s59
    s_and_b32 s90, s2, 3
    s_xor_b32 s42, s2, s57
    s_and_b32 s42, s42, 7
    s_and_b32 s69, s2, 127
    v_lshlrev_b32 v3, 4, v1
    v_lshrrev_b32 v21, 4, v1
    s_cmp_ge_u32 s3, 4
    s_cbranch_scc1 L_cons
    s_setprio 3
    s_movk_i32 s41, 0x1c00
    s_cmp_lt_u32 s2, 128
    s_cselect_b32 s41, 0x2000, s41
    v_and_b32 v22, 15, v1
    v_lshlrev_b32 v22, 4, v22
    s_lshl_b32 s59, s41, 3
    v_mad_u32_u24 v17, v21, s59, v22
    v_lshl_add_u32 v20, v21, 14, v22
    s_lshl_b32 s59, s90, 3
    s_add_u32 s88, s59, s3
    s_mul_i32 s68, s88, s41
    s_lshl_b32 s68, s68, 5
    s_lshl_b32 s59, s91, 8
    s_add_u32 s68, s68, s59
    s_lshl_b32 s59, s41, 7
    s_add_u32 s70, s68, s59
    s_cmp_lt_u32 s2, 240
    s_cselect_b32 s68, s68, 0x7f000000
    s_cselect_b32 s70, s70, 0x7f000000
    s_lshl_b32 s62, s3, 14
    s_add_u32 s62, s62, 16384
    s_cmp_lt_u32 s2, 128
    s_waitcnt lgkmcnt(0)
    s_cselect_b32 s36, s10, s16
    s_cselect_b32 s37, s11, s17
    s_lshl_b32 s38, s41, 10
    s_and_b32 s37, s37, 0xffff
    s_mov_b32 s39, 0x20000
    s_add_u32 m0, s62, 0
    s_nop 0
    buffer_load_dwordx4 v17, s[36:39], s68 offen nt lds
    s_add_u32 s68, s68, s41
    s_add_u32 m0, s62, 1024
    s_nop 0
    buffer_load_dwordx4 v17, s[36:39], s68 offen nt lds
    s_add_u32 s68, s68, s41
    s_add_u32 m0, s62, 2048
    s_nop 0
    buffer_load_dwordx4 v17, s[36:39], s68 offen nt lds
    s_add_u32 s68, s68, s41
    s_add_u32 m0, s62, 3072
    s_nop 0
    buffer_load_dwordx4 v17, s[36:39], s68 offen nt lds
    s_add_u32 m0, s62, 65536
    s_nop 0
    buffer_load_dwordx4 v17, s[36:39], s70 offen nt lds
    s_add_u32 s70, s70, s41
    s_add_u32 m0, s62, 66560
    s_nop 0
    buffer_load_dwordx4 v17, s[36:39], s70 offen nt lds
    v_lshlrev_b32 v2, 6, v21
    v_bfe_u32 v22, v1, 2, 2
    v_lshl_add_u32 v2, v22, 8, v2
    v_and_b32 v22, 3, v1
    v_lshl_add_u32 v2, v22, 4, v2
    s_lshl_b32 s58, s56, 23
    s_lshl_b32 s59, s57, 2
    s_add_u32 s59, s59, s3
    s_lshl_b32 s59, s59, 12
    s_add_u32 s58, s58, s59
    s_mov_b32 s28, s6
    s_and_b32 s29, s7, 0xffff
    s_mov_b32 s30, 0x4000000
    s_mov_b32 s31, 0x20000
    s_mov_b32 s32, s8
    s_and_b32 s33, s9, 0xffff
    s_mov_b32 s34, 0x4000000
    s_mov_b32 s35, 0x20000
    s_mov_b32 s44, s18
    s_and_b32 s45, s19, 0xffff
    s_mov_b32 s46, 0x700000
    s_mov_b32 s47, 0x20000
    s_mov_b32 s48, s12
    s_and_b32 s49, s13, 0xffff
    s_mov_b32 s50, 0x800000
    s_mov_b32 s51, 0x20000
    s_lshl_b32 s64, s57, 18
    s_lshl_b32 s59, s3, 16
    s_add_u32 s64, s64, s59
    s_lshl_b32 s59, s42, 8
    s_add_u32 s64, s64, s59
    s_lshl_b32 s65, s69, 16
    s_lshr_b32 s59, s2, 7
    s_lshl_b32 s59, s59, 10
    s_add_u32 s65, s65, s59
    s_lshl_b32 s59, s3, 8
    s_add_u32 s65, s65, s59
    s_lshl_b32 s59, s3, 2
    v_mov_b32 v4, s59
    s_barrier
    s_add_u32 s70, s70, s41
    s_add_u32 m0, s62, 67584
    s_nop 0
    buffer_load_dwordx4 v17, s[36:39], s70 offen nt lds
    s_add_u32 s70, s70, s41
    s_add_u32 m0, s62, 68608
    s_nop 0
    buffer_load_dwordx4 v17, s[36:39], s70 offen nt lds
    s_add_u32 s68, s68, s41
    s_add_u32 m0, s62, 4096
    s_waitcnt vmcnt(7)
    buffer_load_dwordx4 v17, s[36:39], s68 offen nt lds
    s_add_u32 s68, s68, s41
    s_add_u32 m0, s62, 5120
    s_waitcnt vmcnt(7)
    buffer_load_dwordx4 v17, s[36:39], s68 offen nt lds
    s_add_u32 s68, s68, s41
    s_add_u32 m0, s62, 6144
    s_waitcnt vmcnt(7)
    buffer_load_dwordx4 v17, s[36:39], s68 offen nt lds
    s_add_u32 s68, s68, s41
    s_add_u32 m0, s62, 7168
    s_waitcnt vmcnt(7)
    buffer_load_dwordx4 v17, s[36:39], s68 offen nt lds
    v_mov_b32 v5, 1
    ds_write_b32 v4, v5 offset:32
    s_add_u32 s70, s70, s41
    s_add_u32 m0, s62, 69632
    s_waitcnt vmcnt(7)
    buffer_load_dwordx4 v17, s[36:39], s70 offen nt lds
    s_add_u32 s70, s70, s41
    s_add_u32 m0, s62, 70656
    s_waitcnt vmcnt(7)
    buffer_load_dwordx4 v17, s[36:39], s70 offen nt lds
    s_add_u32 s70, s70, s41
    s_add_u32 m0, s62, 71680
    s_waitcnt vmcnt(7)
    buffer_load_dwordx4 v17, s[36:39], s70 offen nt lds
    s_add_u32 s70, s70, s41
    s_add_u32 m0, s62, 72704
    s_waitcnt vmcnt(7)
    buffer_load_dwordx4 v17, s[36:39], s70 offen nt lds
    v_mov_b32 v5, 1
    ds_write_b32 v4, v5 offset:48
    s_add_u32 s40, s58, 0x0
    s_add_u32 m0, s62, 8192
    s_waitcnt vmcnt(5)
    buffer_load_dwordx4 v2, s[28:31], s40 offen offset:0 nt lds
    s_waitcnt vmcnt(5)
    buffer_load_dwordx4 v2, s[28:31], s40 offen offset:1024 nt lds
    v_mov_b32 v5, 2
    ds_write_b32 v4, v5 offset:32
    s_waitcnt vmcnt(5)
    buffer_load_dwordx4 v2, s[28:31], s40 offen offset:2048 nt lds
    s_waitcnt vmcnt(5)
    buffer_load_dwordx4 v2, s[28:31], s40 offen offset:3072 nt lds
    s_add_u32 s40, s58, 0x80000
    s_add_u32 m0, s62, 73728
    s_waitcnt vmcnt(5)
    buffer_load_dwordx4 v2, s[28:31], s40 offen offset:0 nt lds
    s_waitcnt vmcnt(5)
    buffer_load_dwordx4 v2, s[28:31], s40 offen offset:1024 nt lds
    v_mov_b32 v5, 2
    ds_write_b32 v4, v5 offset:48
    s_waitcnt vmcnt(5)
    buffer_load_dwordx4 v2, s[28:31], s40 offen offset:2048 nt lds
    s_waitcnt vmcnt(5)
    buffer_load_dwordx4 v2, s[28:31], s40 offen offset:3072 nt lds
    s_add_u32 s40, s58, 0x100000
    s_add_u32 m0, s62, 12288
    s_waitcnt vmcnt(5)
    buffer_load_dwordx4 v2, s[28:31], s40 offen offset:0 nt lds
    s_waitcnt vmcnt(5)
    buffer_load_dwordx4 v2, s[28:31], s40 offen offset:1024 nt lds
    v_mov_b32 v5, 3
    ds_write_b32 v4, v5 offset:32
    s_waitcnt vmcnt(5)
    buffer_load_dwordx4 v2, s[28:31], s40 offen offset:2048 nt lds
    s_waitcnt vmcnt(5)
    buffer_load_dwordx4 v2, s[28:31], s40 offen offset:3072 nt lds
    ds_read_b32 v6, v4 offset:64
    s_add_u32 s40, s58, 0x180000
    s_add_u32 m0, s62, 77824
    s_waitcnt vmcnt(5)
    buffer_load_dwordx4 v2, s[28:31], s40 offen offset:0 nt lds
    s_waitcnt vmcnt(5)
    buffer_load_dwordx4 v2, s[28:31], s40 offen offset:1024 nt lds
    v_mov_b32 v5, 3
    ds_write_b32 v4, v5 offset:48
    s_waitcnt vmcnt(5)
    buffer_load_dwordx4 v2, s[28:31], s40 offen offset:2048 nt lds
    s_waitcnt vmcnt(5)
    buffer_load_dwordx4 v2, s[28:31], s40 offen offset:3072 nt lds
    s_waitcnt lgkmcnt(0)
    v_readfirstlane_b32 s59, v6
    s_nop 0
    s_cmp_ge_u32 s59, 1
    s_cbranch_scc1 L_fr1
    s_mov_b32 s88, 1600000
    s_nop 0
L_sw2:
    ds_read_b32 v22, v4 offset:64
    s_waitcnt lgkmcnt(0)
    v_readfirstlane_b32 s59, v22
    s_nop 0
    s_cmp_ge_u32 s59, 1
    s_cbranch_scc1 L_swok2
    s_sub_u32 s88, s88, 1
    s_cbranch_scc0 L_sw2
L_swok2:
L_fr1:
    ds_read_b32 v6, v4 offset:80
    s_add_u32 s40, s58, 0x200000
    s_add_u32 m0, s62, 0
    s_waitcnt vmcnt(5)
    buffer_load_dwordx4 v2, s[28:31], s40 offen offset:0 nt lds
    s_waitcnt vmcnt(5)
    buffer_load_dwordx4 v2, s[28:31], s40 offen offset:1024 nt lds
    v_mov_b32 v5, 4
    ds_write_b32 v4, v5 offset:32
    s_waitcnt vmcnt(5)
    buffer_load_dwordx4 v2, s[28:31], s40 offen offset:2048 nt lds
    s_waitcnt vmcnt(5)
    buffer_load_dwordx4 v2, s[28:31], s40 offen offset:3072 nt lds
    s_waitcnt lgkmcnt(0)
    v_readfirstlane_b32 s59, v6
    s_nop 0
    s_cmp_ge_u32 s59, 1
    s_cbranch_scc1 L_fr3
    s_mov_b32 s88, 1600000
    s_nop 0
L_sw4:
    ds_read_b32 v22, v4 offset:80
    s_waitcnt lgkmcnt(0)
    v_readfirstlane_b32 s59, v22
    s_nop 0
    s_cmp_ge_u32 s59, 1
    s_cbranch_scc1 L_swok4
    s_sub_u32 s88, s88, 1
    s_cbranch_scc0 L_sw4
L_swok4:
L_fr3:
    ds_read_b32 v6, v4 offset:64
    s_add_u32 s40, s58, 0x280000
    s_add_u32 m0, s62, 65536
    s_waitcnt vmcnt(5)
    buffer_load_dwordx4 v2, s[28:31], s40 offen offset:0 nt lds
    s_waitcnt vmcnt(5)
    buffer_load_dwordx4 v2, s[28:31], s40 offen offset:1024 nt lds
    v_mov_b32 v5, 4
    ds_write_b32 v4, v5 offset:48
    s_waitcnt vmcnt(5)
    buffer_load_dwordx4 v2, s[28:31], s40 offen offset:2048 nt lds
    s_waitcnt vmcnt(5)
    buffer_load_dwordx4 v2, s[28:31], s40 offen offset:3072 nt lds
    s_waitcnt lgkmcnt(0)
    v_readfirstlane_b32 s59, v6
    s_nop 0
    s_cmp_ge_u32 s59, 2
    s_cbranch_scc1 L_fr5
    s_mov_b32 s88, 1600000
    s_nop 0
L_sw6:
    ds_read_b32 v22, v4 offset:64
    s_waitcnt lgkmcnt(0)
    v_readfirstlane_b32 s59, v22
    s_nop 0
    s_cmp_ge_u32 s59, 2
    s_cbranch_scc1 L_swok6
    s_sub_u32 s88, s88, 1
    s_cbranch_scc0 L_sw6
L_swok6:
L_fr5:
    ds_read_b32 v6, v4 offset:80
    s_add_u32 s40, s58, 0x300000
    s_add_u32 m0, s62, 4096
    s_waitcnt vmcnt(5)
    buffer_load_dwordx4 v2, s[28:31], s40 offen offset:0 nt lds
    s_waitcnt vmcnt(5)
    buffer_load_dwordx4 v2, s[28:31], s40 offen offset:1024 nt lds
    v_mov_b32 v5, 5
    ds_write_b32 v4, v5 offset:32
    s_waitcnt vmcnt(5)
    buffer_load_dwordx4 v2, s[28:31], s40 offen offset:2048 nt lds
    s_waitcnt vmcnt(5)
    buffer_load_dwordx4 v2, s[28:31], s40 offen offset:3072 nt lds
    s_waitcnt lgkmcnt(0)
    v_readfirstlane_b32 s59, v6
    s_nop 0
    s_cmp_ge_u32 s59, 2
    s_cbranch_scc1 L_fr7
    s_mov_b32 s88, 1600000
    s_nop 0
L_sw8:
    ds_read_b32 v22, v4 offset:80
    s_waitcnt lgkmcnt(0)
    v_readfirstlane_b32 s59, v22
    s_nop 0
    s_cmp_ge_u32 s59, 2
    s_cbranch_scc1 L_swok8
    s_sub_u32 s88, s88, 1
    s_cbranch_scc0 L_sw8
L_swok8:
L_fr7:
    ds_read_b32 v6, v4 offset:64
    s_add_u32 s40, s58, 0x380000
    s_add_u32 m0, s62, 69632
    s_waitcnt vmcnt(5)
    buffer_load_dwordx4 v2, s[28:31], s40 offen offset:0 nt lds
    s_waitcnt vmcnt(5)
    buffer_load_dwordx4 v2, s[28:31], s40 offen offset:1024 nt lds
    v_mov_b32 v5, 5
    ds_write_b32 v4, v5 offset:48
    s_waitcnt vmcnt(5)
    buffer_load_dwordx4 v2, s[28:31], s40 offen offset:2048 nt lds
    s_waitcnt vmcnt(5)
    buffer_load_dwordx4 v2, s[28:31], s40 offen offset:3072 nt lds
    s_waitcnt lgkmcnt(0)
    v_readfirstlane_b32 s59, v6
    s_nop 0
    s_cmp_ge_u32 s59, 3
    s_cbranch_scc1 L_fr9
    s_mov_b32 s88, 1600000
    s_nop 0
L_sw10:
    ds_read_b32 v22, v4 offset:64
    s_waitcnt lgkmcnt(0)
    v_readfirstlane_b32 s59, v22
    s_nop 0
    s_cmp_ge_u32 s59, 3
    s_cbranch_scc1 L_swok10
    s_sub_u32 s88, s88, 1
    s_cbranch_scc0 L_sw10
L_swok10:
L_fr9:
    ds_read_b32 v6, v4 offset:80
    s_add_u32 s40, s58, 0x400000
    s_add_u32 m0, s62, 8192
    s_waitcnt vmcnt(5)
    buffer_load_dwordx4 v2, s[28:31], s40 offen offset:0 nt lds
    s_waitcnt vmcnt(5)
    buffer_load_dwordx4 v2, s[28:31], s40 offen offset:1024 nt lds
    v_mov_b32 v5, 6
    ds_write_b32 v4, v5 offset:32
    s_waitcnt vmcnt(5)
    buffer_load_dwordx4 v2, s[28:31], s40 offen offset:2048 nt lds
    s_waitcnt vmcnt(5)
    buffer_load_dwordx4 v2, s[28:31], s40 offen offset:3072 nt lds
    s_waitcnt lgkmcnt(0)
    v_readfirstlane_b32 s59, v6
    s_nop 0
    s_cmp_ge_u32 s59, 3
    s_cbranch_scc1 L_fr11
    s_mov_b32 s88, 1600000
    s_nop 0
L_sw12:
    ds_read_b32 v22, v4 offset:80
    s_waitcnt lgkmcnt(0)
    v_readfirstlane_b32 s59, v22
    s_nop 0
    s_cmp_ge_u32 s59, 3
    s_cbranch_scc1 L_swok12
    s_sub_u32 s88, s88, 1
    s_cbranch_scc0 L_sw12
L_swok12:
L_fr11:
    ds_read_b32 v6, v4 offset:64
    s_add_u32 s40, s58, 0x480000
    s_add_u32 m0, s62, 73728
    s_waitcnt vmcnt(5)
    buffer_load_dwordx4 v2, s[28:31], s40 offen offset:0 nt lds
    s_waitcnt vmcnt(5)
    buffer_load_dwordx4 v2, s[28:31], s40 offen offset:1024 nt lds
    v_mov_b32 v5, 6
    ds_write_b32 v4, v5 offset:48
    s_waitcnt vmcnt(5)
    buffer_load_dwordx4 v2, s[28:31], s40 offen offset:2048 nt lds
    s_waitcnt vmcnt(5)
    buffer_load_dwordx4 v2, s[28:31], s40 offen offset:3072 nt lds
    s_waitcnt lgkmcnt(0)
    v_readfirstlane_b32 s59, v6
    s_nop 0
    s_cmp_ge_u32 s59, 4
    s_cbranch_scc1 L_fr13
    s_mov_b32 s88, 1600000
    s_nop 0
L_sw14:
    ds_read_b32 v22, v4 offset:64
    s_waitcnt lgkmcnt(0)
    v_readfirstlane_b32 s59, v22
    s_nop 0
    s_cmp_ge_u32 s59, 4
    s_cbranch_scc1 L_swok14
    s_sub_u32 s88, s88, 1
    s_cbranch_scc0 L_sw14
L_swok14:
L_fr13:
    ds_read_b32 v6, v4 offset:80
    s_add_u32 s40, s58, 0x500000
    s_add_u32 m0, s62, 12288
    s_waitcnt vmcnt(5)
    buffer_load_dwordx4 v2, s[28:31], s40 offen offset:0 nt lds
    s_waitcnt vmcnt(5)
    buffer_load_dwordx4 v2, s[28:31], s40 offen offset:1024 nt lds
    v_mov_b32 v5, 7
    ds_write_b32 v4, v5 offset:32
    s_waitcnt vmcnt(5)
    buffer_load_dwordx4 v2, s[28:31], s40 offen offset:2048 nt lds
    s_waitcnt vmcnt(5)
    buffer_load_dwordx4 v2, s[28:31], s40 offen offset:3072 nt lds
    s_waitcnt lgkmcnt(0)
    v_readfirstlane_b32 s59, v6
    s_nop 0
    s_cmp_ge_u32 s59, 4
    s_cbranch_scc1 L_fr15
    s_mov_b32 s88, 1600000
    s_nop 0
L_sw16:
    ds_read_b32 v22, v4 offset:80
    s_waitcnt lgkmcnt(0)
    v_readfirstlane_b32 s59, v22
    s_nop 0
    s_cmp_ge_u32 s59, 4
    s_cbranch_scc1 L_swok16
    s_sub_u32 s88, s88, 1
    s_cbranch_scc0 L_sw16
L_swok16:
L_fr15:
    ds_read_b32 v6, v4 offset:64
    s_add_u32 s40, s58, 0x580000
    s_add_u32 m0, s62, 77824
    s_waitcnt vmcnt(5)
    buffer_load_dwordx4 v2, s[28:31], s40 offen offset:0 nt lds
    s_waitcnt vmcnt(5)
    buffer_load_dwordx4 v2, s[28:31], s40 offen offset:1024 nt lds
    v_mov_b32 v5, 7
    ds_write_b32 v4, v5 offset:48
    s_waitcnt vmcnt(5)
    buffer_load_dwordx4 v2, s[28:31], s40 offen offset:2048 nt lds
    s_waitcnt vmcnt(5)
    buffer_load_dwordx4 v2, s[28:31], s40 offen offset:3072 nt lds
    s_waitcnt lgkmcnt(0)
    v_readfirstlane_b32 s59, v6
    s_nop 0
    s_cmp_ge_u32 s59, 5
    s_cbranch_scc1 L_fr17
    s_mov_b32 s88, 1600000
    s_nop 0
L_sw18:
    ds_read_b32 v22, v4 offset:64
    s_waitcnt lgkmcnt(0)
    v_readfirstlane_b32 s59, v22
    s_nop 0
    s_cmp_ge_u32 s59, 5
    s_cbranch_scc1 L_swok18
    s_sub_u32 s88, s88, 1
    s_cbranch_scc0 L_sw18
L_swok18:
L_fr17:
    ds_read_b32 v6, v4 offset:80
    s_add_u32 s40, s58, 0x600000
    s_add_u32 m0, s62, 0
    s_waitcnt vmcnt(5)
    buffer_load_dwordx4 v2, s[28:31], s40 offen offset:0 nt lds
    s_waitcnt vmcnt(5)
    buffer_load_dwordx4 v2, s[28:31], s40 offen offset:1024 nt lds
    v_mov_b32 v5, 8
    ds_write_b32 v4, v5 offset:32
    s_waitcnt vmcnt(5)
    buffer_load_dwordx4 v2, s[28:31], s40 offen offset:2048 nt lds
    s_waitcnt vmcnt(5)
    buffer_load_dwordx4 v2, s[28:31], s40 offen offset:3072 nt lds
    s_waitcnt lgkmcnt(0)
    v_readfirstlane_b32 s59, v6
    s_nop 0
    s_cmp_ge_u32 s59, 5
    s_cbranch_scc1 L_fr19
    s_mov_b32 s88, 1600000
    s_nop 0
L_sw20:
    ds_read_b32 v22, v4 offset:80
    s_waitcnt lgkmcnt(0)
    v_readfirstlane_b32 s59, v22
    s_nop 0
    s_cmp_ge_u32 s59, 5
    s_cbranch_scc1 L_swok20
    s_sub_u32 s88, s88, 1
    s_cbranch_scc0 L_sw20
L_swok20:
L_fr19:
    ds_read_b32 v6, v4 offset:64
    s_add_u32 s40, s58, 0x680000
    s_add_u32 m0, s62, 65536
    s_waitcnt vmcnt(5)
    buffer_load_dwordx4 v2, s[28:31], s40 offen offset:0 nt lds
    s_waitcnt vmcnt(5)
    buffer_load_dwordx4 v2, s[28:31], s40 offen offset:1024 nt lds
    v_mov_b32 v5, 8
    ds_write_b32 v4, v5 offset:48
    s_waitcnt vmcnt(5)
    buffer_load_dwordx4 v2, s[28:31], s40 offen offset:2048 nt lds
    s_waitcnt vmcnt(5)
    buffer_load_dwordx4 v2, s[28:31], s40 offen offset:3072 nt lds
    s_waitcnt lgkmcnt(0)
    v_readfirstlane_b32 s59, v6
    s_nop 0
    s_cmp_ge_u32 s59, 6
    s_cbranch_scc1 L_fr21
    s_mov_b32 s88, 1600000
    s_nop 0
L_sw22:
    ds_read_b32 v22, v4 offset:64
    s_waitcnt lgkmcnt(0)
    v_readfirstlane_b32 s59, v22
    s_nop 0
    s_cmp_ge_u32 s59, 6
    s_cbranch_scc1 L_swok22
    s_sub_u32 s88, s88, 1
    s_cbranch_scc0 L_sw22
L_swok22:
L_fr21:
    ds_read_b32 v6, v4 offset:80
    s_add_u32 s40, s58, 0x700000
    s_add_u32 m0, s62, 4096
    s_waitcnt vmcnt(5)
    buffer_load_dwordx4 v2, s[28:31], s40 offen offset:0 nt lds
    s_waitcnt vmcnt(5)
    buffer_load_dwordx4 v2, s[28:31], s40 offen offset:1024 nt lds
    v_mov_b32 v5, 9
    ds_write_b32 v4, v5 offset:32
    s_waitcnt vmcnt(5)
    buffer_load_dwordx4 v2, s[28:31], s40 offen offset:2048 nt lds
    s_waitcnt vmcnt(5)
    buffer_load_dwordx4 v2, s[28:31], s40 offen offset:3072 nt lds
    s_waitcnt lgkmcnt(0)
    v_readfirstlane_b32 s59, v6
    s_nop 0
    s_cmp_ge_u32 s59, 6
    s_cbranch_scc1 L_fr23
    s_mov_b32 s88, 1600000
    s_nop 0
L_sw24:
    ds_read_b32 v22, v4 offset:80
    s_waitcnt lgkmcnt(0)
    v_readfirstlane_b32 s59, v22
    s_nop 0
    s_cmp_ge_u32 s59, 6
    s_cbranch_scc1 L_swok24
    s_sub_u32 s88, s88, 1
    s_cbranch_scc0 L_sw24
L_swok24:
L_fr23:
    ds_read_b32 v6, v4 offset:64
    s_add_u32 s40, s58, 0x780000
    s_add_u32 m0, s62, 69632
    s_waitcnt vmcnt(5)
    buffer_load_dwordx4 v2, s[28:31], s40 offen offset:0 nt lds
    s_waitcnt vmcnt(5)
    buffer_load_dwordx4 v2, s[28:31], s40 offen offset:1024 nt lds
    v_mov_b32 v5, 9
    ds_write_b32 v4, v5 offset:48
    s_waitcnt vmcnt(5)
    buffer_load_dwordx4 v2, s[28:31], s40 offen offset:2048 nt lds
    s_waitcnt vmcnt(5)
    buffer_load_dwordx4 v2, s[28:31], s40 offen offset:3072 nt lds
    s_waitcnt lgkmcnt(0)
    v_readfirstlane_b32 s59, v6
    s_nop 0
    s_cmp_ge_u32 s59, 7
    s_cbranch_scc1 L_fr25
    s_mov_b32 s88, 1600000
    s_nop 0
L_sw26:
    ds_read_b32 v22, v4 offset:64
    s_waitcnt lgkmcnt(0)
    v_readfirstlane_b32 s59, v22
    s_nop 0
    s_cmp_ge_u32 s59, 7
    s_cbranch_scc1 L_swok26
    s_sub_u32 s88, s88, 1
    s_cbranch_scc0 L_sw26
L_swok26:
L_fr25:
    ds_read_b32 v6, v4 offset:80
    s_add_u32 s40, s58, 0x0
    s_add_u32 m0, s62, 8192
    s_waitcnt vmcnt(5)
    buffer_load_dwordx4 v3, s[32:35], s40 offen offset:0 nt lds
    s_waitcnt vmcnt(5)
    buffer_load_dwordx4 v3, s[32:35], s40 offen offset:1024 nt lds
    v_mov_b32 v5, 10
    ds_write_b32 v4, v5 offset:32
    s_waitcnt vmcnt(5)
    buffer_load_dwordx4 v3, s[32:35], s40 offen offset:2048 nt lds
    s_waitcnt vmcnt(5)
    buffer_load_dwordx4 v3, s[32:35], s40 offen offset:3072 nt lds
    s_waitcnt lgkmcnt(0)
    v_readfirstlane_b32 s59, v6
    s_nop 0
    s_cmp_ge_u32 s59, 7
    s_cbranch_scc1 L_fr27
    s_mov_b32 s88, 1600000
    s_nop 0
L_sw28:
    ds_read_b32 v22, v4 offset:80
    s_waitcnt lgkmcnt(0)
    v_readfirstlane_b32 s59, v22
    s_nop 0
    s_cmp_ge_u32 s59, 7
    s_cbranch_scc1 L_swok28
    s_sub_u32 s88, s88, 1
    s_cbranch_scc0 L_sw28
L_swok28:
L_fr27:
    ds_read_b32 v6, v4 offset:64
    s_add_u32 s40, s58, 0x80000
    s_add_u32 m0, s62, 73728
    s_waitcnt vmcnt(5)
    buffer_load_dwordx4 v3, s[32:35], s40 offen offset:0 nt lds
    s_waitcnt vmcnt(5)
    buffer_load_dwordx4 v3, s[32:35], s40 offen offset:1024 nt lds
    v_mov_b32 v5, 10
    ds_write_b32 v4, v5 offset:48
    s_waitcnt vmcnt(5)
    buffer_load_dwordx4 v3, s[32:35], s40 offen offset:2048 nt lds
    s_waitcnt vmcnt(5)
    buffer_load_dwordx4 v3, s[32:35], s40 offen offset:3072 nt lds
    s_waitcnt lgkmcnt(0)
    v_readfirstlane_b32 s59, v6
    s_nop 0
    s_cmp_ge_u32 s59, 8
    s_cbranch_scc1 L_fr29
    s_mov_b32 s88, 1600000
    s_nop 0
L_sw30:
    ds_read_b32 v22, v4 offset:64
    s_waitcnt lgkmcnt(0)
    v_readfirstlane_b32 s59, v22
    s_nop 0
    s_cmp_ge_u32 s59, 8
    s_cbranch_scc1 L_swok30
    s_sub_u32 s88, s88, 1
    s_cbranch_scc0 L_sw30
L_swok30:
L_fr29:
    ds_read_b32 v6, v4 offset:80
    s_add_u32 s40, s58, 0x100000
    s_add_u32 m0, s62, 12288
    s_waitcnt vmcnt(5)
    buffer_load_dwordx4 v3, s[32:35], s40 offen offset:0 nt lds
    s_waitcnt vmcnt(5)
    buffer_load_dwordx4 v3, s[32:35], s40 offen offset:1024 nt lds
    v_mov_b32 v5, 11
    ds_write_b32 v4, v5 offset:32
    s_waitcnt vmcnt(5)
    buffer_load_dwordx4 v3, s[32:35], s40 offen offset:2048 nt lds
    s_waitcnt vmcnt(5)
    buffer_load_dwordx4 v3, s[32:35], s40 offen offset:3072 nt lds
    s_waitcnt lgkmcnt(0)
    v_readfirstlane_b32 s59, v6
    s_nop 0
    s_cmp_ge_u32 s59, 8
    s_cbranch_scc1 L_fr31
    s_mov_b32 s88, 1600000
    s_nop 0
L_sw32:
    ds_read_b32 v22, v4 offset:80
    s_waitcnt lgkmcnt(0)
    v_readfirstlane_b32 s59, v22
    s_nop 0
    s_cmp_ge_u32 s59, 8
    s_cbranch_scc1 L_swok32
    s_sub_u32 s88, s88, 1
    s_cbranch_scc0 L_sw32
L_swok32:
L_fr31:
    ds_read_b32 v6, v4 offset:64
    s_add_u32 s40, s58, 0x180000
    s_add_u32 m0, s62, 77824
    s_waitcnt vmcnt(5)
    buffer_load_dwordx4 v3, s[32:35], s40 offen offset:0 nt lds
    s_waitcnt vmcnt(5)
    buffer_load_dwordx4 v3, s[32:35], s40 offen offset:1024 nt lds
    v_mov_b32 v5, 11
    ds_write_b32 v4, v5 offset:48
    s_waitcnt vmcnt(5)
    buffer_load_dwordx4 v3, s[32:35], s40 offen offset:2048 nt lds
    s_waitcnt vmcnt(5)
    buffer_load_dwordx4 v3, s[32:35], s40 offen offset:3072 nt lds
    s_waitcnt lgkmcnt(0)
    v_readfirstlane_b32 s59, v6
    s_nop 0
    s_cmp_ge_u32 s59, 9
    s_cbranch_scc1 L_fr33
    s_mov_b32 s88, 1600000
    s_nop 0
L_sw34:
    ds_read_b32 v22, v4 offset:64
    s_waitcnt lgkmcnt(0)
    v_readfirstlane_b32 s59, v22
    s_nop 0
    s_cmp_ge_u32 s59, 9
    s_cbranch_scc1 L_swok34
    s_sub_u32 s88, s88, 1
    s_cbranch_scc0 L_sw34
L_swok34:
L_fr33:
    ds_read_b32 v6, v4 offset:80
    s_add_u32 s40, s58, 0x200000
    s_add_u32 m0, s62, 0
    s_waitcnt vmcnt(5)
    buffer_load_dwordx4 v3, s[32:35], s40 offen offset:0 nt lds
    s_waitcnt vmcnt(5)
    buffer_load_dwordx4 v3, s[32:35], s40 offen offset:1024 nt lds
    v_mov_b32 v5, 12
    ds_write_b32 v4, v5 offset:32
    s_waitcnt vmcnt(5)
    buffer_load_dwordx4 v3, s[32:35], s40 offen offset:2048 nt lds
    s_waitcnt vmcnt(5)
    buffer_load_dwordx4 v3, s[32:35], s40 offen offset:3072 nt lds
    s_waitcnt lgkmcnt(0)
    v_readfirstlane_b32 s59, v6
    s_nop 0
    s_cmp_ge_u32 s59, 9
    s_cbranch_scc1 L_fr35
    s_mov_b32 s88, 1600000
    s_nop 0
L_sw36:
    ds_read_b32 v22, v4 offset:80
    s_waitcnt lgkmcnt(0)
    v_readfirstlane_b32 s59, v22
    s_nop 0
    s_cmp_ge_u32 s59, 9
    s_cbranch_scc1 L_swok36
    s_sub_u32 s88, s88, 1
    s_cbranch_scc0 L_sw36
L_swok36:
L_fr35:
    ds_read_b32 v6, v4 offset:64
    s_add_u32 s40, s58, 0x280000
    s_add_u32 m0, s62, 65536
    s_waitcnt vmcnt(5)
    buffer_load_dwordx4 v3, s[32:35], s40 offen offset:0 nt lds
    s_waitcnt vmcnt(5)
    buffer_load_dwordx4 v3, s[32:35], s40 offen offset:1024 nt lds
    v_mov_b32 v5, 12
    ds_write_b32 v4, v5 offset:48
    s_waitcnt vmcnt(5)
    buffer_load_dwordx4 v3, s[32:35], s40 offen offset:2048 nt lds
    s_waitcnt vmcnt(5)
    buffer_load_dwordx4 v3, s[32:35], s40 offen offset:3072 nt lds
    s_waitcnt lgkmcnt(0)
    v_readfirstlane_b32 s59, v6
    s_nop 0
    s_cmp_ge_u32 s59, 10
    s_cbranch_scc1 L_fr37
    s_mov_b32 s88, 1600000
    s_nop 0
L_sw38:
    ds_read_b32 v22, v4 offset:64
    s_waitcnt lgkmcnt(0)
    v_readfirstlane_b32 s59, v22
    s_nop 0
    s_cmp_ge_u32 s59, 10
    s_cbranch_scc1 L_swok38
    s_sub_u32 s88, s88, 1
    s_cbranch_scc0 L_sw38
L_swok38:
L_fr37:
    ds_read_b32 v6, v4 offset:80
    s_add_u32 s40, s58, 0x300000
    s_add_u32 m0, s62, 4096
    s_waitcnt vmcnt(5)
    buffer_load_dwordx4 v3, s[32:35], s40 offen offset:0 nt lds
    s_waitcnt vmcnt(5)
    buffer_load_dwordx4 v3, s[32:35], s40 offen offset:1024 nt lds
    v_mov_b32 v5, 13
    ds_write_b32 v4, v5 offset:32
    s_waitcnt vmcnt(5)
    buffer_load_dwordx4 v3, s[32:35], s40 offen offset:2048 nt lds
    s_waitcnt vmcnt(5)
    buffer_load_dwordx4 v3, s[32:35], s40 offen offset:3072 nt lds
    s_waitcnt lgkmcnt(0)
    v_readfirstlane_b32 s59, v6
    s_nop 0
    s_cmp_ge_u32 s59, 10
    s_cbranch_scc1 L_fr39
    s_mov_b32 s88, 1600000
    s_nop 0
L_sw40:
    ds_read_b32 v22, v4 offset:80
    s_waitcnt lgkmcnt(0)
    v_readfirstlane_b32 s59, v22
    s_nop 0
    s_cmp_ge_u32 s59, 10
    s_cbranch_scc1 L_swok40
    s_sub_u32 s88, s88, 1
    s_cbranch_scc0 L_sw40
L_swok40:
L_fr39:
    ds_read_b32 v6, v4 offset:64
    s_add_u32 s40, s58, 0x380000
    s_add_u32 m0, s62, 69632
    s_waitcnt vmcnt(5)
    buffer_load_dwordx4 v3, s[32:35], s40 offen offset:0 nt lds
    s_waitcnt vmcnt(5)
    buffer_load_dwordx4 v3, s[32:35], s40 offen offset:1024 nt lds
    v_mov_b32 v5, 13
    ds_write_b32 v4, v5 offset:48
    s_waitcnt vmcnt(5)
    buffer_load_dwordx4 v3, s[32:35], s40 offen offset:2048 nt lds
    s_waitcnt vmcnt(5)
    buffer_load_dwordx4 v3, s[32:35], s40 offen offset:3072 nt lds
    s_waitcnt lgkmcnt(0)
    v_readfirstlane_b32 s59, v6
    s_nop 0
    s_cmp_ge_u32 s59, 11
    s_cbranch_scc1 L_fr41
    s_mov_b32 s88, 1600000
    s_nop 0
L_sw42:
    ds_read_b32 v22, v4 offset:64
    s_waitcnt lgkmcnt(0)
    v_readfirstlane_b32 s59, v22
    s_nop 0
    s_cmp_ge_u32 s59, 11
    s_cbranch_scc1 L_swok42
    s_sub_u32 s88, s88, 1
    s_cbranch_scc0 L_sw42
L_swok42:
L_fr41:
    ds_read_b32 v6, v4 offset:80
    s_add_u32 s40, s58, 0x400000
    s_add_u32 m0, s62, 8192
    s_waitcnt vmcnt(5)
    buffer_load_dwordx4 v3, s[32:35], s40 offen offset:0 nt lds
    s_waitcnt vmcnt(5)
    buffer_load_dwordx4 v3, s[32:35], s40 offen offset:1024 nt lds
    v_mov_b32 v5, 14
    ds_write_b32 v4, v5 offset:32
    s_waitcnt vmcnt(5)
    buffer_load_dwordx4 v3, s[32:35], s40 offen offset:2048 nt lds
    s_waitcnt vmcnt(5)
    buffer_load_dwordx4 v3, s[32:35], s40 offen offset:3072 nt lds
    s_waitcnt lgkmcnt(0)
    v_readfirstlane_b32 s59, v6
    s_nop 0
    s_cmp_ge_u32 s59, 11
    s_cbranch_scc1 L_fr43
    s_mov_b32 s88, 1600000
    s_nop 0
L_sw44:
    ds_read_b32 v22, v4 offset:80
    s_waitcnt lgkmcnt(0)
    v_readfirstlane_b32 s59, v22
    s_nop 0
    s_cmp_ge_u32 s59, 11
    s_cbranch_scc1 L_swok44
    s_sub_u32 s88, s88, 1
    s_cbranch_scc0 L_sw44
L_swok44:
L_fr43:
    ds_read_b32 v6, v4 offset:64
    s_add_u32 s40, s58, 0x480000
    s_add_u32 m0, s62, 73728
    s_waitcnt vmcnt(5)
    buffer_load_dwordx4 v3, s[32:35], s40 offen offset:0 nt lds
    s_waitcnt vmcnt(5)
    buffer_load_dwordx4 v3, s[32:35], s40 offen offset:1024 nt lds
    v_mov_b32 v5, 14
    ds_write_b32 v4, v5 offset:48
    s_waitcnt vmcnt(5)
    buffer_load_dwordx4 v3, s[32:35], s40 offen offset:2048 nt lds
    s_waitcnt vmcnt(5)
    buffer_load_dwordx4 v3, s[32:35], s40 offen offset:3072 nt lds
    s_waitcnt lgkmcnt(0)
    v_readfirstlane_b32 s59, v6
    s_nop 0
    s_cmp_ge_u32 s59, 12
    s_cbranch_scc1 L_fr45
    s_mov_b32 s88, 1600000
    s_nop 0
L_sw46:
    ds_read_b32 v22, v4 offset:64
    s_waitcnt lgkmcnt(0)
    v_readfirstlane_b32 s59, v22
    s_nop 0
    s_cmp_ge_u32 s59, 12
    s_cbranch_scc1 L_swok46
    s_sub_u32 s88, s88, 1
    s_cbranch_scc0 L_sw46
L_swok46:
L_fr45:
    ds_read_b32 v6, v4 offset:80
    s_add_u32 s40, s58, 0x500000
    s_add_u32 m0, s62, 12288
    s_waitcnt vmcnt(5)
    buffer_load_dwordx4 v3, s[32:35], s40 offen offset:0 nt lds
    s_waitcnt vmcnt(5)
    buffer_load_dwordx4 v3, s[32:35], s40 offen offset:1024 nt lds
    v_mov_b32 v5, 15
    ds_write_b32 v4, v5 offset:32
    s_waitcnt vmcnt(5)
    buffer_load_dwordx4 v3, s[32:35], s40 offen offset:2048 nt lds
    s_waitcnt vmcnt(5)
    buffer_load_dwordx4 v3, s[32:35], s40 offen offset:3072 nt lds
    s_waitcnt lgkmcnt(0)
    v_readfirstlane_b32 s59, v6
    s_nop 0
    s_cmp_ge_u32 s59, 12
    s_cbranch_scc1 L_fr47
    s_mov_b32 s88, 1600000
    s_nop 0
L_sw48:
    ds_read_b32 v22, v4 offset:80
    s_waitcnt lgkmcnt(0)
    v_readfirstlane_b32 s59, v22
    s_nop 0
    s_cmp_ge_u32 s59, 12
    s_cbranch_scc1 L_swok48
    s_sub_u32 s88, s88, 1
    s_cbranch_scc0 L_sw48
L_swok48:
L_fr47:
    ds_read_b32 v6, v4 offset:64
    s_add_u32 s40, s58, 0x580000
    s_add_u32 m0, s62, 77824
    s_waitcnt vmcnt(5)
    buffer_load_dwordx4 v3, s[32:35], s40 offen offset:0 nt lds
    s_waitcnt vmcnt(5)
    buffer_load_dwordx4 v3, s[32:35], s40 offen offset:1024 nt lds
    v_mov_b32 v5, 15
    ds_write_b32 v4, v5 offset:48
    s_waitcnt vmcnt(5)
    buffer_load_dwordx4 v3, s[32:35], s40 offen offset:2048 nt lds
    s_waitcnt vmcnt(5)
    buffer_load_dwordx4 v3, s[32:35], s40 offen offset:3072 nt lds
    s_waitcnt lgkmcnt(0)
    v_readfirstlane_b32 s59, v6
    s_nop 0
    s_cmp_ge_u32 s59, 13
    s_cbranch_scc1 L_fr49
    s_mov_b32 s88, 1600000
    s_nop 0
L_sw50:
    ds_read_b32 v22, v4 offset:64
    s_waitcnt lgkmcnt(0)
    v_readfirstlane_b32 s59, v22
    s_nop 0
    s_cmp_ge_u32 s59, 13
    s_cbranch_scc1 L_swok50
    s_sub_u32 s88, s88, 1
    s_cbranch_scc0 L_sw50
L_swok50:
L_fr49:
    ds_read_b32 v6, v4 offset:80
    s_add_u32 s40, s58, 0x600000
    s_add_u32 m0, s62, 0
    s_waitcnt vmcnt(5)
    buffer_load_dwordx4 v3, s[32:35], s40 offen offset:0 nt lds
    s_waitcnt vmcnt(5)
    buffer_load_dwordx4 v3, s[32:35], s40 offen offset:1024 nt lds
    v_mov_b32 v5, 16
    ds_write_b32 v4, v5 offset:32
    s_waitcnt vmcnt(5)
    buffer_load_dwordx4 v3, s[32:35], s40 offen offset:2048 nt lds
    s_waitcnt vmcnt(5)
    buffer_load_dwordx4 v3, s[32:35], s40 offen offset:3072 nt lds
    s_waitcnt lgkmcnt(0)
    v_readfirstlane_b32 s59, v6
    s_nop 0
    s_cmp_ge_u32 s59, 13
    s_cbranch_scc1 L_fr51
    s_mov_b32 s88, 1600000
    s_nop 0
L_sw52:
    ds_read_b32 v22, v4 offset:80
    s_waitcnt lgkmcnt(0)
    v_readfirstlane_b32 s59, v22
    s_nop 0
    s_cmp_ge_u32 s59, 13
    s_cbranch_scc1 L_swok52
    s_sub_u32 s88, s88, 1
    s_cbranch_scc0 L_sw52
L_swok52:
L_fr51:
    ds_read_b32 v6, v4 offset:64
    s_add_u32 s40, s58, 0x680000
    s_add_u32 m0, s62, 65536
    s_waitcnt vmcnt(5)
    buffer_load_dwordx4 v3, s[32:35], s40 offen offset:0 nt lds
    s_waitcnt vmcnt(5)
    buffer_load_dwordx4 v3, s[32:35], s40 offen offset:1024 nt lds
    v_mov_b32 v5, 16
    ds_write_b32 v4, v5 offset:48
    s_waitcnt vmcnt(5)
    buffer_load_dwordx4 v3, s[32:35], s40 offen offset:2048 nt lds
    s_waitcnt vmcnt(5)
    buffer_load_dwordx4 v3, s[32:35], s40 offen offset:3072 nt lds
    s_waitcnt lgkmcnt(0)
    v_readfirstlane_b32 s59, v6
    s_nop 0
    s_cmp_ge_u32 s59, 14
    s_cbranch_scc1 L_fr53
    s_mov_b32 s88, 1600000
    s_nop 0
L_sw54:
    ds_read_b32 v22, v4 offset:64
    s_waitcnt lgkmcnt(0)
    v_readfirstlane_b32 s59, v22
    s_nop 0
    s_cmp_ge_u32 s59, 14
    s_cbranch_scc1 L_swok54
    s_sub_u32 s88, s88, 1
    s_cbranch_scc0 L_sw54
L_swok54:
L_fr53:
    ds_read_b32 v6, v4 offset:80
    s_add_u32 s40, s58, 0x700000
    s_add_u32 m0, s62, 4096
    s_waitcnt vmcnt(5)
    buffer_load_dwordx4 v3, s[32:35], s40 offen offset:0 nt lds
    s_waitcnt vmcnt(5)
    buffer_load_dwordx4 v3, s[32:35], s40 offen offset:1024 nt lds
    v_mov_b32 v5, 17
    ds_write_b32 v4, v5 offset:32
    s_waitcnt vmcnt(5)
    buffer_load_dwordx4 v3, s[32:35], s40 offen offset:2048 nt lds
    s_waitcnt vmcnt(5)
    buffer_load_dwordx4 v3, s[32:35], s40 offen offset:3072 nt lds
    s_waitcnt lgkmcnt(0)
    v_readfirstlane_b32 s59, v6
    s_nop 0
    s_cmp_ge_u32 s59, 14
    s_cbranch_scc1 L_fr55
    s_mov_b32 s88, 1600000
    s_nop 0
L_sw56:
    ds_read_b32 v22, v4 offset:80
    s_waitcnt lgkmcnt(0)
    v_readfirstlane_b32 s59, v22
    s_nop 0
    s_cmp_ge_u32 s59, 14
    s_cbranch_scc1 L_swok56
    s_sub_u32 s88, s88, 1
    s_cbranch_scc0 L_sw56
L_swok56:
L_fr55:
    ds_read_b32 v6, v4 offset:80
    s_add_u32 s40, s58, 0x780000
    s_add_u32 m0, s62, 69632
    s_waitcnt vmcnt(5)
    buffer_load_dwordx4 v3, s[32:35], s40 offen offset:0 nt lds
    s_waitcnt vmcnt(5)
    buffer_load_dwordx4 v3, s[32:35], s40 offen offset:1024 nt lds
    v_mov_b32 v5, 17
    ds_write_b32 v4, v5 offset:48
    s_waitcnt vmcnt(5)
    buffer_load_dwordx4 v3, s[32:35], s40 offen offset:2048 nt lds
    s_waitcnt vmcnt(5)
    buffer_load_dwordx4 v3, s[32:35], s40 offen offset:3072 nt lds
    s_waitcnt lgkmcnt(0)
    v_readfirstlane_b32 s59, v6
    s_nop 0
    s_cmp_ge_u32 s59, 15
    s_cbranch_scc1 L_fr57
    s_mov_b32 s88, 1600000
    s_nop 0
L_sw58:
    ds_read_b32 v22, v4 offset:80
    s_waitcnt lgkmcnt(0)
    v_readfirstlane_b32 s59, v22
    s_nop 0
    s_cmp_ge_u32 s59, 15
    s_cbranch_scc1 L_swok58
    s_sub_u32 s88, s88, 1
    s_cbranch_scc0 L_sw58
L_swok58:
L_fr57:
    ds_read_b32 v6, v4 offset:80
    s_add_u32 s40, s65, 0
    s_add_u32 m0, s62, 73728
    s_waitcnt vmcnt(5)
    buffer_load_dwordx4 v20, s[48:51], s40 offen nt lds
    s_add_u32 s40, s65, 2048
    s_add_u32 m0, s62, 74752
    s_waitcnt vmcnt(5)
    buffer_load_dwordx4 v20, s[48:51], s40 offen nt lds
    v_mov_b32 v5, 18
    ds_write_b32 v4, v5 offset:32
    s_add_u32 s40, s65, 4096
    s_add_u32 m0, s62, 75776
    s_waitcnt vmcnt(5)
    buffer_load_dwordx4 v20, s[48:51], s40 offen nt lds
    s_add_u32 s40, s65, 6144
    s_add_u32 m0, s62, 76800
    s_waitcnt vmcnt(5)
    buffer_load_dwordx4 v20, s[48:51], s40 offen nt lds
    s_waitcnt lgkmcnt(0)
    v_readfirstlane_b32 s59, v6
    s_nop 0
    s_cmp_ge_u32 s59, 16
    s_cbranch_scc1 L_fr59
    s_mov_b32 s88, 1600000
    s_nop 0
L_sw60:
    ds_read_b32 v22, v4 offset:80
    s_waitcnt lgkmcnt(0)
    v_readfirstlane_b32 s59, v22
    s_nop 0
    s_cmp_ge_u32 s59, 16
    s_cbranch_scc1 L_swok60
    s_sub_u32 s88, s88, 1
    s_cbranch_scc0 L_sw60
L_swok60:
L_fr59:
    ds_read_b32 v6, v4 offset:64
    s_add_u32 s40, s65, 8192
    s_add_u32 m0, s62, 77824
    s_waitcnt vmcnt(5)
    buffer_load_dwordx4 v20, s[48:51], s40 offen nt lds
    s_add_u32 s40, s65, 10240
    s_add_u32 m0, s62, 78848
    s_waitcnt vmcnt(5)
    buffer_load_dwordx4 v20, s[48:51], s40 offen nt lds
    v_mov_b32 v5, 18
    ds_write_b32 v4, v5 offset:48
    s_add_u32 s40, s65, 12288
    s_add_u32 m0, s62, 79872
    s_waitcnt vmcnt(5)
    buffer_load_dwordx4 v20, s[48:51], s40 offen nt lds
    s_add_u32 s40, s65, 14336
    s_add_u32 m0, s62, 80896
    s_waitcnt vmcnt(5)
    buffer_load_dwordx4 v20, s[48:51], s40 offen nt lds
    s_waitcnt lgkmcnt(0)
    v_readfirstlane_b32 s59, v6
    s_nop 0
    s_cmp_ge_u32 s59, 15
    s_cbranch_scc1 L_fr61
    s_mov_b32 s88, 1600000
    s_nop 0
L_sw62:
    ds_read_b32 v22, v4 offset:64
    s_waitcnt lgkmcnt(0)
    v_readfirstlane_b32 s59, v22
    s_nop 0
    s_cmp_ge_u32 s59, 15
    s_cbranch_scc1 L_swok62
    s_sub_u32 s88, s88, 1
    s_cbranch_scc0 L_sw62
L_swok62:
L_fr61:
    ds_read_b32 v6, v4 offset:64
    s_add_u32 s40, s64, 0
    s_add_u32 m0, s62, 8192
    s_waitcnt vmcnt(5)
    buffer_load_dwordx4 v20, s[44:47], s40 offen nt lds
    s_add_u32 s40, s64, 2048
    s_add_u32 m0, s62, 9216
    s_waitcnt vmcnt(5)
    buffer_load_dwordx4 v20, s[44:47], s40 offen nt lds
    v_mov_b32 v5, 19
    ds_write_b32 v4, v5 offset:48
    s_add_u32 s40, s64, 4096
    s_add_u32 m0, s62, 10240
    s_waitcnt vmcnt(5)
    buffer_load_dwordx4 v20, s[44:47], s40 offen nt lds
    s_add_u32 s40, s64, 6144
    s_add_u32 m0, s62, 11264
    s_waitcnt vmcnt(5)
    buffer_load_dwordx4 v20, s[44:47], s40 offen nt lds
    s_waitcnt lgkmcnt(0)
    v_readfirstlane_b32 s59, v6
    s_nop 0
    s_cmp_ge_u32 s59, 16
    s_cbranch_scc1 L_fr63
    s_mov_b32 s88, 1600000
    s_nop 0
L_sw64:
    ds_read_b32 v22, v4 offset:64
    s_waitcnt lgkmcnt(0)
    v_readfirstlane_b32 s59, v22
    s_nop 0
    s_cmp_ge_u32 s59, 16
    s_cbranch_scc1 L_swok64
    s_sub_u32 s88, s88, 1
    s_cbranch_scc0 L_sw64
L_swok64:
L_fr63:
    s_add_u32 s40, s64, 8192
    s_add_u32 m0, s62, 12288
    s_waitcnt vmcnt(5)
    buffer_load_dwordx4 v20, s[44:47], s40 offen nt lds
    s_add_u32 s40, s64, 10240
    s_add_u32 m0, s62, 13312
    s_waitcnt vmcnt(5)
    buffer_load_dwordx4 v20, s[44:47], s40 offen nt lds
    v_mov_b32 v5, 20
    ds_write_b32 v4, v5 offset:48
    s_add_u32 s40, s64, 12288
    s_add_u32 m0, s62, 14336
    s_waitcnt vmcnt(5)
    buffer_load_dwordx4 v20, s[44:47], s40 offen nt lds
    s_add_u32 s40, s64, 14336
    s_add_u32 m0, s62, 15360
    s_waitcnt vmcnt(5)
    buffer_load_dwordx4 v20, s[44:47], s40 offen nt lds
    s_waitcnt vmcnt(4)
    v_mov_b32 v5, 19
    ds_write_b32 v4, v5 offset:32
    s_waitcnt vmcnt(0)
    v_mov_b32 v5, 20
    ds_write_b32 v4, v5 offset:32
    s_branch L_fin
L_cons:
    s_sub_u32 s3, s3, 4
    s_and_b32 s43, s3, 3
    v_subrev_u32 v0, 256, v0
    v_lshlrev_b32 v16, 2, v0
    s_lshl_b32 s59, s90, 3
    s_add_u32 s88, s59, s3
    v_and_b32 v18, 1, v1
    v_lshlrev_b32 v19, 11, v18
    v_lshl_add_u32 v19, v21, 4, v19
    s_lshl_b32 s59, s88, 6
    v_add_u32 v19, s59, v19
    v_mov_b32 v17, 0
    v_lshlrev_b32 v18, 2, v1
    s_mov_b32 exec_hi, 0
    ds_write_b32 v18, v17
    s_mov_b64 exec, -1
    s_waitcnt lgkmcnt(0)
    global_load_dword v14, v16, s[4:5]
    global_load_dword v15, v16, s[4:5] offset:2048
    global_load_dwordx4 v[10:13], v19, s[4:5]
    global_load_dword v9, v17, s[24:25] sc1
    s_barrier
    s_mov_b32 s52, s24
    s_and_b32 s53, s25, 0xffff
    s_mov_b32 s54, 0x700000
    s_mov_b32 s55, 0x20000
    s_mov_b32 s63, 0x05040100
    s_mov_b32 s64, 0x07060302
    s_mov_b32 s65, 0x3db504f3
    s_mov_b32 s66, 0x3fb8aa3b
    s_mov_b32 s67, 0xfffff000
    s_mov_b32 s72, 0x30003
    s_mov_b32 s73, 0x30003
    s_mov_b32 s74, 0xc000c
    s_mov_b32 s75, 0xc000c
    s_mov_b32 s76, 0x300030
    s_mov_b32 s77, 0x300030
    s_mov_b32 s78, 0xc000c0
    s_mov_b32 s79, 0xc000c0
    s_mov_b32 s80, 0x3000300
    s_mov_b32 s81, 0x3000300
    s_mov_b32 s82, 0xc000c00
    s_mov_b32 s83, 0xc000c00
    s_mov_b32 s84, 0x30003000
    s_mov_b32 s85, 0x30003000
    s_mov_b32 s86, 0xc000c000
    s_mov_b32 s87, 0xc000c000
    v_and_b32 v21, 8, v1
    v_cmp_eq_u32 vcc, 0, v21
    v_mov_b32 v21, 0xffff0000
    v_mov_b32 v22, 0xffff
    v_cndmask_b32 v4, v21, v22, vcc
    s_lshl_b32 s59, s3, 14
    s_add_u32 s59, s59, 16384
    v_add_u32 v2, s59, v3
    s_lshl_b32 s59, s3, 2
    v_mov_b32 v20, s59
    s_mov_b32 s40, 0
    v_and_b32 v16, 15, v1
    v_lshlrev_b32 v16, 3, v16
    s_lshl_b32 s59, s3, 4
    v_mov_b32 v18, s59
    s_waitcnt vmcnt(2)
    v_lshlrev_b32 v64, 16, v14
    v_and_b32 v65, 0xffff0000, v14
    v_lshlrev_b32 v66, 16, v15
    v_and_b32 v67, 0xffff0000, v15
    v_add_f32 v40, v64, v65
    v_add_f32 v42, v66, v67
    s_nop 0
    v_add_f32_dpp v40, v40, v40 row_ror:8 row_mask:0xf bank_mask:0xf
    v_add_f32_dpp v42, v42, v42 row_ror:8 row_mask:0xf bank_mask:0xf
    s_nop 0
    v_add_f32_dpp v40, v40, v40 row_ror:4 row_mask:0xf bank_mask:0xf
    v_add_f32_dpp v42, v42, v42 row_ror:4 row_mask:0xf bank_mask:0xf
    s_nop 0
    v_add_f32_dpp v40, v40, v40 row_ror:2 row_mask:0xf bank_mask:0xf
    v_add_f32_dpp v42, v42, v42 row_ror:2 row_mask:0xf bank_mask:0xf
    s_nop 0
    v_add_f32_dpp v40, v40, v40 row_ror:1 row_mask:0xf bank_mask:0xf
    v_add_f32_dpp v42, v42, v42 row_ror:1 row_mask:0xf bank_mask:0xf
    v_mov_b32 v44, v40
    v_mov_b32 v45, v42
    s_nop 0
    v_permlane16_swap_b32 v40, v44
    v_permlane16_swap_b32 v42, v45
    v_add_f32 v40, v40, v44
    v_add_f32 v42, v42, v45
    v_mov_b32 v44, v40
    v_mov_b32 v45, v42
    s_nop 0
    v_permlane32_swap_b32 v40, v44
    v_permlane32_swap_b32 v42, v45
    v_add_f32 v40, v40, v44
    v_add_f32 v42, v42, v45
    v_mul_f32 v40, 0x3c000000, v40
    v_mul_f32 v42, 0x3c000000, v42
    v_sub_f32 v64, v64, v40
    v_sub_f32 v65, v65, v40
    v_sub_f32 v66, v66, v42
    v_sub_f32 v67, v67, v42
    v_mul_f32 v41, v64, v64
    v_mul_f32 v43, v66, v66
    v_fmac_f32 v41, v65, v65
    v_fmac_f32 v43, v67, v67
    s_nop 0
    v_add_f32_dpp v41, v41, v41 row_ror:8 row_mask:0xf bank_mask:0xf
    v_add_f32_dpp v43, v43, v43 row_ror:8 row_mask:0xf bank_mask:0xf
    s_nop 0
    v_add_f32_dpp v41, v41, v41 row_ror:4 row_mask:0xf bank_mask:0xf
    v_add_f32_dpp v43, v43, v43 row_ror:4 row_mask:0xf bank_mask:0xf
    s_nop 0
    v_add_f32_dpp v41, v41, v41 row_ror:2 row_mask:0xf bank_mask:0xf
    v_add_f32_dpp v43, v43, v43 row_ror:2 row_mask:0xf bank_mask:0xf
    s_nop 0
    v_add_f32_dpp v41, v41, v41 row_ror:1 row_mask:0xf bank_mask:0xf
    v_add_f32_dpp v43, v43, v43 row_ror:1 row_mask:0xf bank_mask:0xf
    v_mov_b32 v44, v41
    v_mov_b32 v45, v43
    s_nop 0
    v_permlane16_swap_b32 v41, v44
    v_permlane16_swap_b32 v43, v45
    v_add_f32 v41, v41, v44
    v_add_f32 v43, v43, v45
    v_mov_b32 v44, v41
    v_mov_b32 v45, v43
    s_nop 0
    v_permlane32_swap_b32 v41, v44
    v_permlane32_swap_b32 v43, v45
    v_add_f32 v41, v41, v44
    v_add_f32 v43, v43, v45
    s_mov_b64 exec, 1
    ds_write_b128 v18, v[40:43] offset:128
    s_mov_b64 exec, -1
    v_mov_b32 v21, 24
    v_mov_b32 v22, 1
    s_mov_b64 exec, 1
    ds_add_u32 v21, v22
    s_mov_b64 exec, -1
    s_waitcnt vmcnt(0)
    v_lshlrev_b32 v48, 16, v10
    v_and_b32 v49, 0xffff0000, v10
    v_lshlrev_b32 v50, 16, v11
    v_and_b32 v51, 0xffff0000, v11
    v_lshlrev_b32 v52, 16, v12
    v_and_b32 v53, 0xffff0000, v12
    v_lshlrev_b32 v54, 16, v13
    v_and_b32 v55, 0xffff0000, v13
    v_readfirstlane_b32 s60, v9
    v_mov_b32 v21, 0
    s_mov_b32 s88, 1600000
    s_nop 2
L_sw65:
    ds_read_b32 v22, v21 offset:24
    s_waitcnt lgkmcnt(0)
    v_readfirstlane_b32 s59, v22
    s_nop 0
    s_cmp_ge_u32 s59, 8
    s_cbranch_scc1 L_swok65
    s_sub_u32 s88, s88, 1
    s_cbranch_scc0 L_sw65
L_swok65:
    s_add_u32 s60, s60, 1
    s_and_b32 s61, s60, 0xfff
    ds_read_b64 v[40:41], v16 offset:128
    s_waitcnt lgkmcnt(0)
    v_add_f32_dpp v44, v40, v40 row_ror:8 row_mask:0xf bank_mask:0xf
    s_nop 1
    v_add_f32_dpp v44, v44, v44 row_ror:4 row_mask:0xf bank_mask:0xf
    s_nop 1
    v_add_f32_dpp v44, v44, v44 row_ror:2 row_mask:0xf bank_mask:0xf
    v_mul_f32 v44, 0x3e000000, v44
    v_sub_f32 v40, v40, v44
    v_mul_f32 v40, v40, v40
    v_mul_f32 v40, 0x43000000, v40
    v_add_f32 v45, v40, v41
    s_nop 1
    v_add_f32_dpp v45, v45, v45 row_ror:8 row_mask:0xf bank_mask:0xf
    s_nop 1
    v_add_f32_dpp v45, v45, v45 row_ror:4 row_mask:0xf bank_mask:0xf
    s_nop 1
    v_add_f32_dpp v45, v45, v45 row_ror:2 row_mask:0xf bank_mask:0xf
    v_mul_f32 v45, 0x3a800000, v45
    v_cvt_pk_bf16_f32 v16, v45, v44
    v_lshlrev_b32 v45, 16, v16
    v_and_b32 v44, 0xffff0000, v16
    v_add_f32 v45, 0x3727c5ac, v45
    v_cvt_pk_bf16_f32 v45, v45, v45
    v_and_b32 v45, 0xffff0000, v45
    v_sqrt_f32 v45, v45
    v_sub_f32 v48, v48, v44
    v_sub_f32 v49, v49, v44
    v_sub_f32 v50, v50, v44
    v_sub_f32 v51, v51, v44
    v_sub_f32 v52, v52, v44
    v_sub_f32 v53, v53, v44
    v_sub_f32 v54, v54, v44
    v_sub_f32 v55, v55, v44
    v_cvt_pk_bf16_f32 v45, v45, v45
    v_and_b32 v45, 0xffff0000, v45
    v_rcp_f32 v46, v45
    v_cvt_pk_bf16_f32 v16, v48, v49
    v_lshlrev_b32 v48, 16, v16
    v_and_b32 v49, 0xffff0000, v16
    v_cvt_pk_bf16_f32 v17, v50, v51
    v_lshlrev_b32 v50, 16, v17
    v_and_b32 v51, 0xffff0000, v17
    v_cvt_pk_bf16_f32 v16, v52, v53
    v_lshlrev_b32 v52, 16, v16
    v_and_b32 v53, 0xffff0000, v16
    v_cvt_pk_bf16_f32 v17, v54, v55
    v_lshlrev_b32 v54, 16, v17
    v_and_b32 v55, 0xffff0000, v17
    v_mul_f32 v56, v48, v46
    v_mul_f32 v57, v49, v46
    v_mul_f32 v58, v50, v46
    v_mul_f32 v59, v51, v46
    v_mul_f32 v60, v52, v46
    v_mul_f32 v61, v53, v46
    v_mul_f32 v62, v54, v46
    v_mul_f32 v63, v55, v46
    v_fma_f32 v48, -v56, v45, v48
    v_fma_f32 v49, -v57, v45, v49
    v_fma_f32 v50, -v58, v45, v50
    v_fma_f32 v51, -v59, v45, v51
    v_fma_f32 v52, -v60, v45, v52
    v_fma_f32 v53, -v61, v45, v53
    v_fma_f32 v54, -v62, v45, v54
    v_fma_f32 v55, -v63, v45, v55
    v_fma_f32 v48, v48, v46, v56
    v_fma_f32 v49, v49, v46, v57
    v_fma_f32 v50, v50, v46, v58
    v_fma_f32 v51, v51, v46, v59
    v_fma_f32 v52, v52, v46, v60
    v_fma_f32 v53, v53, v46, v61
    v_fma_f32 v54, v54, v46, v62
    v_fma_f32 v55, v55, v46, v63
    v_cvt_pk_bf16_f32 v10, v48, v49
    v_cvt_pk_bf16_f32 v11, v50, v51
    v_cvt_pk_bf16_f32 v12, v52, v53
    v_cvt_pk_bf16_f32 v13, v54, v55
    v_cndmask_b32 v64, 0, v10, s[72:73]
    v_cndmask_b32 v65, 0, v11, s[72:73]
    v_cndmask_b32 v66, 0, v12, s[72:73]
    v_cndmask_b32 v67, 0, v13, s[72:73]
    v_cndmask_b32 v68, 0, v10, s[74:75]
    v_cndmask_b32 v69, 0, v11, s[74:75]
    v_cndmask_b32 v70, 0, v12, s[74:75]
    v_cndmask_b32 v71, 0, v13, s[74:75]
    v_cndmask_b32 v72, 0, v10, s[76:77]
    v_cndmask_b32 v73, 0, v11, s[76:77]
    v_cndmask_b32 v74, 0, v12, s[76:77]
    v_cndmask_b32 v75, 0, v13, s[76:77]
    v_cndmask_b32 v76, 0, v10, s[78:79]
    v_cndmask_b32 v77, 0, v11, s[78:79]
    v_cndmask_b32 v78, 0, v12, s[78:79]
    v_cndmask_b32 v79, 0, v13, s[78:79]
    v_cndmask_b32 v80, 0, v10, s[80:81]
    v_cndmask_b32 v81, 0, v11, s[80:81]
    v_cndmask_b32 v82, 0, v12, s[80:81]
    v_cndmask_b32 v83, 0, v13, s[80:81]
    v_cndmask_b32 v84, 0, v10, s[82:83]
    v_cndmask_b32 v85, 0, v11, s[82:83]
    v_cndmask_b32 v86, 0, v12, s[82:83]
    v_cndmask_b32 v87, 0, v13, s[82:83]
    v_cndmask_b32 v88, 0, v10, s[84:85]
    v_cndmask_b32 v89, 0, v11, s[84:85]
    v_cndmask_b32 v90, 0, v12, s[84:85]
    v_cndmask_b32 v91, 0, v13, s[84:85]
    v_cndmask_b32 v92, 0, v10, s[86:87]
    v_cndmask_b32 v93, 0, v11, s[86:87]
    v_cndmask_b32 v94, 0, v12, s[86:87]
    v_cndmask_b32 v95, 0, v13, s[86:87]
    s_cmp_ge_u32 s40, 1
    s_cbranch_scc1 L_nd66
    s_mov_b32 s88, 1600000
L_sw67:
    ds_read_b32 v22, v20 offset:32
    s_waitcnt lgkmcnt(0)
    v_readfirstlane_b32 s40, v22
    s_nop 0
    s_cmp_ge_u32 s40, 1
    s_cbranch_scc1 L_swok67
    s_sleep 1
    s_sub_u32 s88, s88, 1
    s_cbranch_scc0 L_sw67
L_swok67:
L_nd66:
    ds_read_b128 v[96:99], v2 offset:0
    ds_read_b128 v[100:103], v2 offset:1024
    ds_read_b128 v[104:107], v2 offset:2048
    ds_read_b128 v[108:111], v2 offset:3072
    v_mov_b32 v22, 1
    ds_write_b32 v20, v22 offset:64
    s_cmp_ge_u32 s40, 2
    s_cbranch_scc1 L_nd68
    s_mov_b32 s88, 1600000
L_sw69:
    ds_read_b32 v22, v20 offset:32
    s_waitcnt lgkmcnt(0)
    v_readfirstlane_b32 s40, v22
    s_nop 0
    s_cmp_ge_u32 s40, 2
    s_cbranch_scc1 L_swok69
    s_sleep 1
    s_sub_u32 s88, s88, 1
    s_cbranch_scc0 L_sw69
L_swok69:
L_nd68:
    ds_read_b128 v[112:115], v2 offset:4096
    ds_read_b128 v[116:119], v2 offset:5120
    ds_read_b128 v[120:123], v2 offset:6144
    ds_read_b128 v[124:127], v2 offset:7168
    v_mov_b32 v22, 2
    ds_write_b32 v20, v22 offset:64
    s_lshl_b32 s59, s3, 10
    v_add_u32 v17, s59, v3
    v_and_b32 v22, 15, v1
    v_lshlrev_b32 v22, 6, v22
    v_lshrrev_b32 v21, 4, v1
    v_lshl_add_u32 v15, v21, 4, v22
    s_waitcnt lgkmcnt(0)
    v_perm_b32 v24, v100, v96, s63
    v_perm_b32 v25, v108, v104, s63
    v_perm_b32 v26, v116, v112, s63
    v_perm_b32 v27, v124, v120, s63
    v_perm_b32 v28, v100, v96, s64
    v_perm_b32 v29, v108, v104, s64
    v_perm_b32 v30, v116, v112, s64
    v_perm_b32 v31, v124, v120, s64
    v_perm_b32 v32, v101, v97, s63
    v_perm_b32 v33, v109, v105, s63
    v_perm_b32 v34, v117, v113, s63
    v_perm_b32 v35, v125, v121, s63
    v_perm_b32 v36, v101, v97, s64
    v_perm_b32 v37, v109, v105, s64
    v_perm_b32 v38, v117, v113, s64
    v_perm_b32 v39, v125, v121, s64
    v_perm_b32 v48, v102, v98, s63
    v_perm_b32 v49, v110, v106, s63
    v_perm_b32 v50, v118, v114, s63
    v_perm_b32 v51, v126, v122, s63
    v_perm_b32 v52, v102, v98, s64
    v_perm_b32 v53, v110, v106, s64
    v_perm_b32 v54, v118, v114, s64
    v_perm_b32 v55, v126, v122, s64
    v_perm_b32 v56, v103, v99, s63
    v_perm_b32 v57, v111, v107, s63
    v_perm_b32 v58, v119, v115, s63
    v_perm_b32 v59, v127, v123, s63
    v_perm_b32 v60, v103, v99, s64
    v_perm_b32 v61, v111, v107, s64
    v_perm_b32 v62, v119, v115, s64
    v_perm_b32 v63, v127, v123, s64
    v_mfma_f32_16x16x32_bf16 v[40:43], v[64:67], v[24:27], 0
    v_mfma_f32_16x16x32_bf16 v[40:43], v[68:71], v[28:31], v[40:43]
    v_mfma_f32_16x16x32_bf16 v[40:43], v[72:75], v[32:35], v[40:43]
    v_mfma_f32_16x16x32_bf16 v[40:43], v[76:79], v[36:39], v[40:43]
    v_mfma_f32_16x16x32_bf16 v[40:43], v[80:83], v[48:51], v[40:43]
    v_mfma_f32_16x16x32_bf16 v[40:43], v[84:87], v[52:55], v[40:43]
    v_mfma_f32_16x16x32_bf16 v[40:43], v[88:91], v[56:59], v[40:43]
    v_mfma_f32_16x16x32_bf16 v[40:43], v[92:95], v[60:63], v[40:43]
    s_nop 7
    ds_write_b128 v17, v[40:43] offset:8192
    v_mov_b32 v21, 0
    v_mov_b32 v22, 1
    s_mov_b64 exec, 1
    ds_add_rtn_u32 v22, v21, v22
    s_mov_b64 exec, -1
    s_waitcnt lgkmcnt(0)
    v_readfirstlane_b32 s59, v22
    s_nop 0
    s_cmp_eq_u32 s59, 7
    s_cbranch_scc0 L_skipq
    ds_read_b128 v[64:67], v3 offset:8192
    ds_read_b128 v[68:71], v3 offset:9216
    ds_read_b128 v[72:75], v3 offset:10240
    ds_read_b128 v[76:79], v3 offset:11264
    ds_read_b128 v[80:83], v3 offset:12288
    ds_read_b128 v[84:87], v3 offset:13312
    ds_read_b128 v[88:91], v3 offset:14336
    ds_read_b128 v[92:95], v3 offset:15360
    s_lshr_b32 s59, s2, 7
    s_lshl_b32 s59, s59, 18
    s_lshl_b32 s70, s90, 16
    s_add_u32 s59, s59, s70
    s_lshl_b32 s70, s91, 10
    s_add_u32 s59, s59, s70
    s_add_u32 s59, s59, 0x40000
    s_add_u32 s70, s59, 0x8000
    s_waitcnt lgkmcnt(6)
    v_pk_add_f32 v[64:65], v[64:65], v[68:69]
    v_pk_add_f32 v[66:67], v[66:67], v[70:71]
    s_waitcnt lgkmcnt(4)
    v_pk_add_f32 v[72:73], v[72:73], v[76:77]
    v_pk_add_f32 v[74:75], v[74:75], v[78:79]
    s_waitcnt lgkmcnt(2)
    v_pk_add_f32 v[80:81], v[80:81], v[84:85]
    v_pk_add_f32 v[82:83], v[82:83], v[86:87]
    s_waitcnt lgkmcnt(0)
    v_pk_add_f32 v[88:89], v[88:89], v[92:93]
    v_pk_add_f32 v[90:91], v[90:91], v[94:95]
    v_pk_add_f32 v[64:65], v[64:65], v[72:73]
    v_pk_add_f32 v[66:67], v[66:67], v[74:75]
    v_pk_add_f32 v[80:81], v[80:81], v[88:89]
    v_pk_add_f32 v[82:83], v[82:83], v[90:91]
    v_pk_add_f32 v[64:65], v[64:65], v[80:81]
    v_pk_add_f32 v[66:67], v[66:67], v[82:83]
    v_mov_b32 v68, v65
    v_mov_b32 v70, v67
    v_mov_b32 v65, s60
    v_mov_b32 v67, s60
    v_mov_b32 v69, s60
    v_mov_b32 v71, s60
    buffer_store_dwordx4 v[64:67], v15, s[52:55], s59 offen sc1
    buffer_store_dwordx4 v[68:71], v15, s[52:55], s70 offen sc1
L_skipq:
    s_cmp_ge_u32 s40, 3
    s_cbranch_scc1 L_nd70
    s_mov_b32 s88, 1600000
L_sw71:
    ds_read_b32 v22, v20 offset:32
    s_waitcnt lgkmcnt(0)
    v_readfirstlane_b32 s40, v22
    s_nop 0
    s_cmp_ge_u32 s40, 3
    s_cbranch_scc1 L_swok71
    s_sleep 1
    s_sub_u32 s88, s88, 1
    s_cbranch_scc0 L_sw71
L_swok71:
L_nd70:
    ds_read_b128 v[96:99], v2 offset:8192
    ds_read_b128 v[100:103], v2 offset:9216
    ds_read_b128 v[104:107], v2 offset:10240
    ds_read_b128 v[108:111], v2 offset:11264
    v_mov_b32 v22, 3
    ds_write_b32 v20, v22 offset:64
    s_cmp_ge_u32 s40, 4
    s_cbranch_scc1 L_nd72
    s_mov_b32 s88, 1600000
L_sw73:
    ds_read_b32 v22, v20 offset:32
    s_waitcnt lgkmcnt(0)
    v_readfirstlane_b32 s40, v22
    s_nop 0
    s_cmp_ge_u32 s40, 4
    s_cbranch_scc1 L_swok73
    s_sleep 1
    s_sub_u32 s88, s88, 1
    s_cbranch_scc0 L_sw73
L_swok73:
L_nd72:
    ds_read_b128 v[112:115], v2 offset:12288
    ds_read_b128 v[116:119], v2 offset:13312
    ds_read_b128 v[120:123], v2 offset:14336
    ds_read_b128 v[124:127], v2 offset:15360
    v_mov_b32 v22, 4
    ds_write_b32 v20, v22 offset:64
    s_cmp_lg_u32 s3, 0
    s_cbranch_scc1 L_nored
    v_lshrrev_b32 v21, 4, v1
    v_and_b32 v22, 15, v1
    v_lshlrev_b32 v19, 16, v21
    v_lshl_add_u32 v19, v22, 4, v19
    s_lshl_b32 s41, s91, 10
    s_lshl_b32 s59, s90, 8
    s_add_u32 s41, s41, s59
    s_lshr_b32 s62, s2, 7
    s_lshl_b32 s59, s62, 18
    s_add_u32 s70, s41, s59
    s_add_u32 s70, s70, 0x40000
    s_add_u32 s71, s70, 0x8000
    s_mov_b32 s88, 200000
L_mp74:
    buffer_load_dwordx4 v[64:67], v19, s[52:55], s70 offen sc1
    buffer_load_dwordx4 v[68:71], v19, s[52:55], s71 offen sc1
    s_waitcnt vmcnt(0)
    v_min3_u32 v21, v65, v67, v69
    v_min_u32 v21, v21, v71
    v_max3_u32 v22, v65, v67, v69
    v_max_u32 v22, v22, v71
    v_cmp_ne_u32 vcc, s60, v21
    v_cmp_ne_u32 s[92:93], s60, v22
    s_nop 0
    s_or_b64 vcc, vcc, s[92:93]
    s_and_b64 exec, exec, vcc
    s_cbranch_scc0 L_mok74
    s_sleep 4
    s_sub_u32 s88, s88, 1
    s_cbranch_scc0 L_mp74
L_mok74:
    s_mov_b64 exec, -1
    v_mov_b32 v65, v64
    v_mov_b32 v67, v66
    v_mov_b32 v69, v68
    v_mov_b32 v71, v70
    v_permlane16_swap_b32 v64, v65
    v_permlane16_swap_b32 v66, v67
    v_permlane16_swap_b32 v68, v69
    v_permlane16_swap_b32 v70, v71
    v_add_f32 v64, v64, v65
    v_add_f32 v66, v66, v67
    v_add_f32 v68, v68, v69
    v_add_f32 v70, v70, v71
    v_mov_b32 v65, v64
    v_mov_b32 v67, v66
    v_mov_b32 v69, v68
    v_mov_b32 v71, v70
    v_permlane32_swap_b32 v64, v65
    v_permlane32_swap_b32 v66, v67
    v_permlane32_swap_b32 v68, v69
    v_permlane32_swap_b32 v70, v71
    v_add_f32 v64, v64, v65
    v_add_f32 v66, v66, v67
    v_add_f32 v68, v68, v69
    v_add_f32 v70, v70, v71
    s_cmp_eq_u32 s62, 0
    s_cbranch_scc1 L_nosilu
    v_cvt_pk_bf16_f32 v16, v64, v66
    v_lshlrev_b32 v64, 16, v16
    v_and_b32 v66, 0xffff0000, v16
    v_cvt_pk_bf16_f32 v17, v68, v70
    v_lshlrev_b32 v68, 16, v17
    v_and_b32 v70, 0xffff0000, v17
    v_mul_f32 v65, s66, v64
    v_mul_f32 v67, s66, v66
    v_mul_f32 v69, s66, v68
    v_mul_f32 v71, s66, v70
    v_exp_f32 v65, -v65
    v_exp_f32 v67, -v67
    v_exp_f32 v69, -v69
    v_exp_f32 v71, -v71
    v_add_f32 v65, 1.0, v65
    v_add_f32 v67, 1.0, v67
    v_add_f32 v69, 1.0, v69
    v_add_f32 v71, 1.0, v71
    v_rcp_f32 v65, v65
    v_rcp_f32 v67, v67
    v_rcp_f32 v69, v69
    v_rcp_f32 v71, v71
    v_mul_f32 v64, v64, v65
    v_mul_f32 v66, v66, v67
    v_mul_f32 v68, v68, v69
    v_mul_f32 v70, v70, v71
L_nosilu:
    v_cvt_pk_bf16_f32 v64, v64, v66
    v_cvt_pk_bf16_f32 v66, v68, v70
    v_mov_b32 v65, s60
    v_mov_b32 v67, s60
    s_lshl_b32 s59, s62, 15
    s_add_u32 s41, s41, s59
    s_add_u32 s41, s41, 0xc0000
    s_mov_b64 exec, 0xffff
    buffer_store_dwordx4 v[64:67], v3, s[52:55], s41 offen sc1
    s_mov_b64 exec, -1
L_nored:
    s_cmp_ge_u32 s40, 5
    s_cbranch_scc1 L_nd75
    s_mov_b32 s88, 1600000
L_sw76:
    ds_read_b32 v22, v20 offset:32
    s_waitcnt lgkmcnt(0)
    v_readfirstlane_b32 s40, v22
    s_nop 0
    s_cmp_ge_u32 s40, 5
    s_cbranch_scc1 L_swok76
    s_sleep 1
    s_sub_u32 s88, s88, 1
    s_cbranch_scc0 L_sw76
L_swok76:
L_nd75:
    ds_read_b128 v[128:131], v2 offset:0
    ds_read_b128 v[132:135], v2 offset:1024
    ds_read_b128 v[136:139], v2 offset:2048
    ds_read_b128 v[140:143], v2 offset:3072
    v_mov_b32 v22, 5
    ds_write_b32 v20, v22 offset:64
    s_cmp_ge_u32 s40, 6
    s_cbranch_scc1 L_nd77
    s_mov_b32 s88, 1600000
L_sw78:
    ds_read_b32 v22, v20 offset:32
    s_waitcnt lgkmcnt(0)
    v_readfirstlane_b32 s40, v22
    s_nop 0
    s_cmp_ge_u32 s40, 6
    s_cbranch_scc1 L_swok78
    s_sleep 1
    s_sub_u32 s88, s88, 1
    s_cbranch_scc0 L_sw78
L_swok78:
L_nd77:
    ds_read_b128 v[144:147], v2 offset:4096
    ds_read_b128 v[148:151], v2 offset:5120
    ds_read_b128 v[152:155], v2 offset:6144
    ds_read_b128 v[156:159], v2 offset:7168
    v_mov_b32 v22, 6
    ds_write_b32 v20, v22 offset:64
    s_and_b32 s70, s56, 3
    s_lshl_b32 s70, s70, 13
    s_lshl_b32 s59, s3, 10
    s_add_u32 s70, s70, s59
    s_add_u32 s70, s70, 0xc0000
    s_mov_b32 s88, 1600000
L_sw79:
    ds_read_b32 v22, v20 offset:32
    s_waitcnt lgkmcnt(0)
    v_readfirstlane_b32 s40, v22
    s_nop 0
    s_cmp_ge_u32 s40, 7
    s_cbranch_scc1 L_swok79
    s_sleep 1
    s_sub_u32 s88, s88, 1
    s_cbranch_scc0 L_sw79
L_swok79:
    buffer_load_dwordx4 v[64:67], v3, s[52:55], s70 offen sc1
    s_mov_b32 s88, 200000
    s_branch L_mc80
L_mp80:
    buffer_load_dwordx4 v[64:67], v3, s[52:55], s70 offen sc1
L_mc80:
    s_waitcnt vmcnt(0)
    v_min_u32 v21, v65, v67
    v_max_u32 v22, v65, v67
    v_cmp_ne_u32 vcc, s60, v21
    v_cmp_ne_u32 s[92:93], s60, v22
    s_nop 0
    s_or_b64 vcc, vcc, s[92:93]
    s_and_b64 exec, exec, vcc
    s_cbranch_scc0 L_mok80
    s_sleep 8
    s_sub_u32 s88, s88, 1
    s_cbranch_scc0 L_mp80
L_mok80:
    s_mov_b64 exec, -1
    s_cmp_ge_u32 s56, 4
    s_cselect_b64 vcc, -1, 0
    v_cndmask_b32 v64, v64, v66, vcc
    v_lshlrev_b32 v21, 2, v0
    ds_write_b32 v21, v64 offset:2048
    v_mov_b32 v21, 4
    v_mov_b32 v22, 1
    s_mov_b64 exec, 1
    ds_add_u32 v21, v22
    s_mov_b64 exec, -1
    v_and_b32 v18, 3, v1
    v_lshlrev_b32 v18, 8, v18
    v_lshrrev_b32 v19, 2, v1
    v_lshl_add_u32 v18, v19, 4, v18
    v_mov_b32 v21, 0
    s_mov_b32 s88, 1600000
    s_nop 0
L_sw81:
    ds_read_b32 v22, v21 offset:4
    s_waitcnt lgkmcnt(0)
    v_readfirstlane_b32 s59, v22
    s_nop 0
    s_cmp_ge_u32 s59, 8
    s_cbranch_scc1 L_swok81
    s_sub_u32 s88, s88, 1
    s_cbranch_scc0 L_sw81
L_swok81:
    ds_read_b128 v[40:43], v18 offset:2048
    ds_read_b128 v[44:47], v18 offset:3072
    s_waitcnt lgkmcnt(0)
    v_mfma_f32_16x16x32_bf16 v[64:67], v[96:99], v[40:43], 0
    v_mfma_f32_16x16x32_bf16 v[68:71], v[96:99], v[44:47], 0
    v_mfma_f32_16x16x32_bf16 v[72:75], v[100:103], v[40:43], 0
    v_mfma_f32_16x16x32_bf16 v[76:79], v[100:103], v[44:47], 0
    v_mfma_f32_16x16x32_bf16 v[80:83], v[104:107], v[40:43], 0
    v_mfma_f32_16x16x32_bf16 v[84:87], v[104:107], v[44:47], 0
    v_mfma_f32_16x16x32_bf16 v[88:91], v[108:111], v[40:43], 0
    v_mfma_f32_16x16x32_bf16 v[92:95], v[108:111], v[44:47], 0
    s_nop 0
    v_add_f32_dpp v48, v67, v64 row_ror:4 row_mask:0xf bank_mask:0x1
    s_nop 2
    v_add_f32_dpp v49, v83, v80 row_ror:4 row_mask:0xf bank_mask:0x1
    v_add_f32_dpp v48, v68, v69 row_ror:4 row_mask:0xf bank_mask:0x2
    s_nop 0
    v_add_f32_dpp v49, v84, v85 row_ror:4 row_mask:0xf bank_mask:0x2
    v_add_f32_dpp v48, v73, v74 row_ror:4 row_mask:0xf bank_mask:0x4
    s_nop 0
    v_add_f32_dpp v49, v89, v90 row_ror:4 row_mask:0xf bank_mask:0x4
    v_add_f32_dpp v48, v78, v79 row_ror:4 row_mask:0xf bank_mask:0x8
    s_nop 0
    v_add_f32_dpp v49, v94, v95 row_ror:4 row_mask:0xf bank_mask:0x8
    v_add_f32_dpp v48, v66, v48 row_ror:8 row_mask:0xf bank_mask:0x1
    s_nop 0
    v_add_f32_dpp v49, v82, v49 row_ror:8 row_mask:0xf bank_mask:0x1
    v_add_f32_dpp v48, v71, v48 row_ror:8 row_mask:0xf bank_mask:0x2
    s_nop 0
    v_add_f32_dpp v49, v87, v49 row_ror:8 row_mask:0xf bank_mask:0x2
    v_add_f32_dpp v48, v72, v48 row_ror:8 row_mask:0xf bank_mask:0x4
    s_nop 0
    v_add_f32_dpp v49, v88, v49 row_ror:8 row_mask:0xf bank_mask:0x4
    v_add_f32_dpp v48, v77, v48 row_ror:8 row_mask:0xf bank_mask:0x8
    s_nop 0
    v_add_f32_dpp v49, v93, v49 row_ror:8 row_mask:0xf bank_mask:0x8
    v_add_f32_dpp v48, v65, v48 row_ror:12 row_mask:0xf bank_mask:0x1
    s_nop 0
    v_add_f32_dpp v49, v81, v49 row_ror:12 row_mask:0xf bank_mask:0x1
    v_add_f32_dpp v48, v70, v48 row_ror:12 row_mask:0xf bank_mask:0x2
    s_nop 0
    v_add_f32_dpp v49, v86, v49 row_ror:12 row_mask:0xf bank_mask:0x2
    v_add_f32_dpp v48, v75, v48 row_ror:12 row_mask:0xf bank_mask:0x4
    s_nop 0
    v_add_f32_dpp v49, v91, v49 row_ror:12 row_mask:0xf bank_mask:0x4
    v_add_f32_dpp v48, v76, v48 row_ror:12 row_mask:0xf bank_mask:0x8
    s_nop 0
    v_add_f32_dpp v49, v92, v49 row_ror:12 row_mask:0xf bank_mask:0x8
    v_cvt_pk_bf16_f32 v16, v48, v49
    v_lshlrev_b32 v48, 16, v16
    v_and_b32 v49, 0xffff0000, v16
    v_mul_f32 v48, s65, v48
    v_mul_f32 v49, s65, v49
    v_cvt_pk_bf16_f32 v16, v48, v49
    v_lshlrev_b32 v48, 16, v16
    v_and_b32 v49, 0xffff0000, v16
    v_mfma_f32_16x16x32_bf16 v[64:67], v[112:115], v[40:43], 0
    v_mfma_f32_16x16x32_bf16 v[68:71], v[112:115], v[44:47], 0
    v_mfma_f32_16x16x32_bf16 v[72:75], v[116:119], v[40:43], 0
    v_mfma_f32_16x16x32_bf16 v[76:79], v[116:119], v[44:47], 0
    v_mfma_f32_16x16x32_bf16 v[80:83], v[120:123], v[40:43], 0
    v_mfma_f32_16x16x32_bf16 v[84:87], v[120:123], v[44:47], 0
    v_mfma_f32_16x16x32_bf16 v[88:91], v[124:127], v[40:43], 0
    v_mfma_f32_16x16x32_bf16 v[92:95], v[124:127], v[44:47], 0
    s_nop 0
    v_add_f32_dpp v50, v67, v64 row_ror:4 row_mask:0xf bank_mask:0x1
    s_nop 2
    v_add_f32_dpp v51, v83, v80 row_ror:4 row_mask:0xf bank_mask:0x1
    v_add_f32_dpp v50, v68, v69 row_ror:4 row_mask:0xf bank_mask:0x2
    s_nop 0
    v_add_f32_dpp v51, v84, v85 row_ror:4 row_mask:0xf bank_mask:0x2
    v_add_f32_dpp v50, v73, v74 row_ror:4 row_mask:0xf bank_mask:0x4
    s_nop 0
    v_add_f32_dpp v51, v89, v90 row_ror:4 row_mask:0xf bank_mask:0x4
    v_add_f32_dpp v50, v78, v79 row_ror:4 row_mask:0xf bank_mask:0x8
    s_nop 0
    v_add_f32_dpp v51, v94, v95 row_ror:4 row_mask:0xf bank_mask:0x8
    v_add_f32_dpp v50, v66, v50 row_ror:8 row_mask:0xf bank_mask:0x1
    s_nop 0
    v_add_f32_dpp v51, v82, v51 row_ror:8 row_mask:0xf bank_mask:0x1
    v_add_f32_dpp v50, v71, v50 row_ror:8 row_mask:0xf bank_mask:0x2
    s_nop 0
    v_add_f32_dpp v51, v87, v51 row_ror:8 row_mask:0xf bank_mask:0x2
    v_add_f32_dpp v50, v72, v50 row_ror:8 row_mask:0xf bank_mask:0x4
    s_nop 0
    v_add_f32_dpp v51, v88, v51 row_ror:8 row_mask:0xf bank_mask:0x4
    v_add_f32_dpp v50, v77, v50 row_ror:8 row_mask:0xf bank_mask:0x8
    s_nop 0
    v_add_f32_dpp v51, v93, v51 row_ror:8 row_mask:0xf bank_mask:0x8
    v_add_f32_dpp v50, v65, v50 row_ror:12 row_mask:0xf bank_mask:0x1
    s_nop 0
    v_add_f32_dpp v51, v81, v51 row_ror:12 row_mask:0xf bank_mask:0x1
    v_add_f32_dpp v50, v70, v50 row_ror:12 row_mask:0xf bank_mask:0x2
    s_nop 0
    v_add_f32_dpp v51, v86, v51 row_ror:12 row_mask:0xf bank_mask:0x2
    v_add_f32_dpp v50, v75, v50 row_ror:12 row_mask:0xf bank_mask:0x4
    s_nop 0
    v_add_f32_dpp v51, v91, v51 row_ror:12 row_mask:0xf bank_mask:0x4
    v_add_f32_dpp v50, v76, v50 row_ror:12 row_mask:0xf bank_mask:0x8
    s_nop 0
    v_add_f32_dpp v51, v92, v51 row_ror:12 row_mask:0xf bank_mask:0x8
    v_cvt_pk_bf16_f32 v16, v50, v51
    v_lshlrev_b32 v50, 16, v16
    v_and_b32 v51, 0xffff0000, v16
    v_mul_f32 v50, s65, v50
    v_mul_f32 v51, s65, v51
    v_cvt_pk_bf16_f32 v16, v50, v51
    v_lshlrev_b32 v50, 16, v16
    v_and_b32 v51, 0xffff0000, v16
    v_mfma_f32_16x16x32_bf16 v[64:67], v[128:131], v[40:43], 0
    v_mfma_f32_16x16x32_bf16 v[68:71], v[128:131], v[44:47], 0
    v_mfma_f32_16x16x32_bf16 v[72:75], v[132:135], v[40:43], 0
    v_mfma_f32_16x16x32_bf16 v[76:79], v[132:135], v[44:47], 0
    v_mfma_f32_16x16x32_bf16 v[80:83], v[136:139], v[40:43], 0
    v_mfma_f32_16x16x32_bf16 v[84:87], v[136:139], v[44:47], 0
    v_mfma_f32_16x16x32_bf16 v[88:91], v[140:143], v[40:43], 0
    v_mfma_f32_16x16x32_bf16 v[92:95], v[140:143], v[44:47], 0
    s_nop 0
    v_add_f32_dpp v52, v67, v64 row_ror:4 row_mask:0xf bank_mask:0x1
    s_nop 2
    v_add_f32_dpp v53, v83, v80 row_ror:4 row_mask:0xf bank_mask:0x1
    v_add_f32_dpp v52, v68, v69 row_ror:4 row_mask:0xf bank_mask:0x2
    s_nop 0
    v_add_f32_dpp v53, v84, v85 row_ror:4 row_mask:0xf bank_mask:0x2
    v_add_f32_dpp v52, v73, v74 row_ror:4 row_mask:0xf bank_mask:0x4
    s_nop 0
    v_add_f32_dpp v53, v89, v90 row_ror:4 row_mask:0xf bank_mask:0x4
    v_add_f32_dpp v52, v78, v79 row_ror:4 row_mask:0xf bank_mask:0x8
    s_nop 0
    v_add_f32_dpp v53, v94, v95 row_ror:4 row_mask:0xf bank_mask:0x8
    v_add_f32_dpp v52, v66, v52 row_ror:8 row_mask:0xf bank_mask:0x1
    s_nop 0
    v_add_f32_dpp v53, v82, v53 row_ror:8 row_mask:0xf bank_mask:0x1
    v_add_f32_dpp v52, v71, v52 row_ror:8 row_mask:0xf bank_mask:0x2
    s_nop 0
    v_add_f32_dpp v53, v87, v53 row_ror:8 row_mask:0xf bank_mask:0x2
    v_add_f32_dpp v52, v72, v52 row_ror:8 row_mask:0xf bank_mask:0x4
    s_nop 0
    v_add_f32_dpp v53, v88, v53 row_ror:8 row_mask:0xf bank_mask:0x4
    v_add_f32_dpp v52, v77, v52 row_ror:8 row_mask:0xf bank_mask:0x8
    s_nop 0
    v_add_f32_dpp v53, v93, v53 row_ror:8 row_mask:0xf bank_mask:0x8
    v_add_f32_dpp v52, v65, v52 row_ror:12 row_mask:0xf bank_mask:0x1
    s_nop 0
    v_add_f32_dpp v53, v81, v53 row_ror:12 row_mask:0xf bank_mask:0x1
    v_add_f32_dpp v52, v70, v52 row_ror:12 row_mask:0xf bank_mask:0x2
    s_nop 0
    v_add_f32_dpp v53, v86, v53 row_ror:12 row_mask:0xf bank_mask:0x2
    v_add_f32_dpp v52, v75, v52 row_ror:12 row_mask:0xf bank_mask:0x4
    s_nop 0
    v_add_f32_dpp v53, v91, v53 row_ror:12 row_mask:0xf bank_mask:0x4
    v_add_f32_dpp v52, v76, v52 row_ror:12 row_mask:0xf bank_mask:0x8
    s_nop 0
    v_add_f32_dpp v53, v92, v53 row_ror:12 row_mask:0xf bank_mask:0x8
    v_cvt_pk_bf16_f32 v16, v52, v53
    v_lshlrev_b32 v52, 16, v16
    v_and_b32 v53, 0xffff0000, v16
    v_mul_f32 v52, s65, v52
    v_mul_f32 v53, s65, v53
    v_cvt_pk_bf16_f32 v16, v52, v53
    v_lshlrev_b32 v52, 16, v16
    v_and_b32 v53, 0xffff0000, v16
    v_mfma_f32_16x16x32_bf16 v[64:67], v[144:147], v[40:43], 0
    v_mfma_f32_16x16x32_bf16 v[68:71], v[144:147], v[44:47], 0
    v_mfma_f32_16x16x32_bf16 v[72:75], v[148:151], v[40:43], 0
    v_mfma_f32_16x16x32_bf16 v[76:79], v[148:151], v[44:47], 0
    v_mfma_f32_16x16x32_bf16 v[80:83], v[152:155], v[40:43], 0
    v_mfma_f32_16x16x32_bf16 v[84:87], v[152:155], v[44:47], 0
    v_mfma_f32_16x16x32_bf16 v[88:91], v[156:159], v[40:43], 0
    v_mfma_f32_16x16x32_bf16 v[92:95], v[156:159], v[44:47], 0
    s_nop 0
    v_add_f32_dpp v54, v67, v64 row_ror:4 row_mask:0xf bank_mask:0x1
    s_nop 2
    v_add_f32_dpp v55, v83, v80 row_ror:4 row_mask:0xf bank_mask:0x1
    v_add_f32_dpp v54, v68, v69 row_ror:4 row_mask:0xf bank_mask:0x2
    s_nop 0
    v_add_f32_dpp v55, v84, v85 row_ror:4 row_mask:0xf bank_mask:0x2
    v_add_f32_dpp v54, v73, v74 row_ror:4 row_mask:0xf bank_mask:0x4
    s_nop 0
    v_add_f32_dpp v55, v89, v90 row_ror:4 row_mask:0xf bank_mask:0x4
    v_add_f32_dpp v54, v78, v79 row_ror:4 row_mask:0xf bank_mask:0x8
    s_nop 0
    v_add_f32_dpp v55, v94, v95 row_ror:4 row_mask:0xf bank_mask:0x8
    v_add_f32_dpp v54, v66, v54 row_ror:8 row_mask:0xf bank_mask:0x1
    s_nop 0
    v_add_f32_dpp v55, v82, v55 row_ror:8 row_mask:0xf bank_mask:0x1
    v_add_f32_dpp v54, v71, v54 row_ror:8 row_mask:0xf bank_mask:0x2
    s_nop 0
    v_add_f32_dpp v55, v87, v55 row_ror:8 row_mask:0xf bank_mask:0x2
    v_add_f32_dpp v54, v72, v54 row_ror:8 row_mask:0xf bank_mask:0x4
    s_nop 0
    v_add_f32_dpp v55, v88, v55 row_ror:8 row_mask:0xf bank_mask:0x4
    v_add_f32_dpp v54, v77, v54 row_ror:8 row_mask:0xf bank_mask:0x8
    s_nop 0
    v_add_f32_dpp v55, v93, v55 row_ror:8 row_mask:0xf bank_mask:0x8
    v_add_f32_dpp v54, v65, v54 row_ror:12 row_mask:0xf bank_mask:0x1
    s_nop 0
    v_add_f32_dpp v55, v81, v55 row_ror:12 row_mask:0xf bank_mask:0x1
    v_add_f32_dpp v54, v70, v54 row_ror:12 row_mask:0xf bank_mask:0x2
    s_nop 0
    v_add_f32_dpp v55, v86, v55 row_ror:12 row_mask:0xf bank_mask:0x2
    v_add_f32_dpp v54, v75, v54 row_ror:12 row_mask:0xf bank_mask:0x4
    s_nop 0
    v_add_f32_dpp v55, v91, v55 row_ror:12 row_mask:0xf bank_mask:0x4
    v_add_f32_dpp v54, v76, v54 row_ror:12 row_mask:0xf bank_mask:0x8
    s_nop 0
    v_add_f32_dpp v55, v92, v55 row_ror:12 row_mask:0xf bank_mask:0x8
    v_cvt_pk_bf16_f32 v16, v54, v55
    v_lshlrev_b32 v54, 16, v16
    v_and_b32 v55, 0xffff0000, v16
    v_mul_f32 v54, s65, v54
    v_mul_f32 v55, s65, v55
    v_cvt_pk_bf16_f32 v16, v54, v55
    v_lshlrev_b32 v54, 16, v16
    v_and_b32 v55, 0xffff0000, v16
    s_cmp_ge_u32 s40, 7
    s_cbranch_scc1 L_nd82
    s_mov_b32 s88, 1600000
L_sw83:
    ds_read_b32 v22, v20 offset:32
    s_waitcnt lgkmcnt(0)
    v_readfirstlane_b32 s40, v22
    s_nop 0
    s_cmp_ge_u32 s40, 7
    s_cbranch_scc1 L_swok83
    s_sleep 1
    s_sub_u32 s88, s88, 1
    s_cbranch_scc0 L_sw83
L_swok83:
L_nd82:
    ds_read_b128 v[96:99], v2 offset:8192
    ds_read_b128 v[100:103], v2 offset:9216
    ds_read_b128 v[104:107], v2 offset:10240
    ds_read_b128 v[108:111], v2 offset:11264
    v_mov_b32 v22, 7
    ds_write_b32 v20, v22 offset:64
    s_waitcnt lgkmcnt(0)
    v_mfma_f32_16x16x32_bf16 v[64:67], v[96:99], v[40:43], 0
    v_mfma_f32_16x16x32_bf16 v[68:71], v[96:99], v[44:47], 0
    v_mfma_f32_16x16x32_bf16 v[72:75], v[100:103], v[40:43], 0
    v_mfma_f32_16x16x32_bf16 v[76:79], v[100:103], v[44:47], 0
    v_mfma_f32_16x16x32_bf16 v[80:83], v[104:107], v[40:43], 0
    v_mfma_f32_16x16x32_bf16 v[84:87], v[104:107], v[44:47], 0
    v_mfma_f32_16x16x32_bf16 v[88:91], v[108:111], v[40:43], 0
    v_mfma_f32_16x16x32_bf16 v[92:95], v[108:111], v[44:47], 0
    s_nop 0
    v_add_f32_dpp v56, v67, v64 row_ror:4 row_mask:0xf bank_mask:0x1
    s_nop 2
    v_add_f32_dpp v57, v83, v80 row_ror:4 row_mask:0xf bank_mask:0x1
    v_add_f32_dpp v56, v68, v69 row_ror:4 row_mask:0xf bank_mask:0x2
    s_nop 0
    v_add_f32_dpp v57, v84, v85 row_ror:4 row_mask:0xf bank_mask:0x2
    v_add_f32_dpp v56, v73, v74 row_ror:4 row_mask:0xf bank_mask:0x4
    s_nop 0
    v_add_f32_dpp v57, v89, v90 row_ror:4 row_mask:0xf bank_mask:0x4
    v_add_f32_dpp v56, v78, v79 row_ror:4 row_mask:0xf bank_mask:0x8
    s_nop 0
    v_add_f32_dpp v57, v94, v95 row_ror:4 row_mask:0xf bank_mask:0x8
    v_add_f32_dpp v56, v66, v56 row_ror:8 row_mask:0xf bank_mask:0x1
    s_nop 0
    v_add_f32_dpp v57, v82, v57 row_ror:8 row_mask:0xf bank_mask:0x1
    v_add_f32_dpp v56, v71, v56 row_ror:8 row_mask:0xf bank_mask:0x2
    s_nop 0
    v_add_f32_dpp v57, v87, v57 row_ror:8 row_mask:0xf bank_mask:0x2
    v_add_f32_dpp v56, v72, v56 row_ror:8 row_mask:0xf bank_mask:0x4
    s_nop 0
    v_add_f32_dpp v57, v88, v57 row_ror:8 row_mask:0xf bank_mask:0x4
    v_add_f32_dpp v56, v77, v56 row_ror:8 row_mask:0xf bank_mask:0x8
    s_nop 0
    v_add_f32_dpp v57, v93, v57 row_ror:8 row_mask:0xf bank_mask:0x8
    v_add_f32_dpp v56, v65, v56 row_ror:12 row_mask:0xf bank_mask:0x1
    s_nop 0
    v_add_f32_dpp v57, v81, v57 row_ror:12 row_mask:0xf bank_mask:0x1
    v_add_f32_dpp v56, v70, v56 row_ror:12 row_mask:0xf bank_mask:0x2
    s_nop 0
    v_add_f32_dpp v57, v86, v57 row_ror:12 row_mask:0xf bank_mask:0x2
    v_add_f32_dpp v56, v75, v56 row_ror:12 row_mask:0xf bank_mask:0x4
    s_nop 0
    v_add_f32_dpp v57, v91, v57 row_ror:12 row_mask:0xf bank_mask:0x4
    v_add_f32_dpp v56, v76, v56 row_ror:12 row_mask:0xf bank_mask:0x8
    s_nop 0
    v_add_f32_dpp v57, v92, v57 row_ror:12 row_mask:0xf bank_mask:0x8
    v_cvt_pk_bf16_f32 v16, v56, v57
    v_lshlrev_b32 v56, 16, v16
    v_and_b32 v57, 0xffff0000, v16
    v_mul_f32 v56, s65, v56
    v_mul_f32 v57, s65, v57
    v_cvt_pk_bf16_f32 v16, v56, v57
    v_lshlrev_b32 v56, 16, v16
    v_and_b32 v57, 0xffff0000, v16
    s_cmp_ge_u32 s40, 8
    s_cbranch_scc1 L_nd84
    s_mov_b32 s88, 1600000
L_sw85:
    ds_read_b32 v22, v20 offset:32
    s_waitcnt lgkmcnt(0)
    v_readfirstlane_b32 s40, v22
    s_nop 0
    s_cmp_ge_u32 s40, 8
    s_cbranch_scc1 L_swok85
    s_sleep 1
    s_sub_u32 s88, s88, 1
    s_cbranch_scc0 L_sw85
L_swok85:
L_nd84:
    ds_read_b128 v[112:115], v2 offset:12288
    ds_read_b128 v[116:119], v2 offset:13312
    ds_read_b128 v[120:123], v2 offset:14336
    ds_read_b128 v[124:127], v2 offset:15360
    v_mov_b32 v22, 8
    ds_write_b32 v20, v22 offset:64
    s_waitcnt lgkmcnt(0)
    v_mfma_f32_16x16x32_bf16 v[64:67], v[112:115], v[40:43], 0
    v_mfma_f32_16x16x32_bf16 v[68:71], v[112:115], v[44:47], 0
    v_mfma_f32_16x16x32_bf16 v[72:75], v[116:119], v[40:43], 0
    v_mfma_f32_16x16x32_bf16 v[76:79], v[116:119], v[44:47], 0
    v_mfma_f32_16x16x32_bf16 v[80:83], v[120:123], v[40:43], 0
    v_mfma_f32_16x16x32_bf16 v[84:87], v[120:123], v[44:47], 0
    v_mfma_f32_16x16x32_bf16 v[88:91], v[124:127], v[40:43], 0
    v_mfma_f32_16x16x32_bf16 v[92:95], v[124:127], v[44:47], 0
    s_nop 0
    v_add_f32_dpp v58, v67, v64 row_ror:4 row_mask:0xf bank_mask:0x1
    s_nop 2
    v_add_f32_dpp v59, v83, v80 row_ror:4 row_mask:0xf bank_mask:0x1
    v_add_f32_dpp v58, v68, v69 row_ror:4 row_mask:0xf bank_mask:0x2
    s_nop 0
    v_add_f32_dpp v59, v84, v85 row_ror:4 row_mask:0xf bank_mask:0x2
    v_add_f32_dpp v58, v73, v74 row_ror:4 row_mask:0xf bank_mask:0x4
    s_nop 0
    v_add_f32_dpp v59, v89, v90 row_ror:4 row_mask:0xf bank_mask:0x4
    v_add_f32_dpp v58, v78, v79 row_ror:4 row_mask:0xf bank_mask:0x8
    s_nop 0
    v_add_f32_dpp v59, v94, v95 row_ror:4 row_mask:0xf bank_mask:0x8
    v_add_f32_dpp v58, v66, v58 row_ror:8 row_mask:0xf bank_mask:0x1
    s_nop 0
    v_add_f32_dpp v59, v82, v59 row_ror:8 row_mask:0xf bank_mask:0x1
    v_add_f32_dpp v58, v71, v58 row_ror:8 row_mask:0xf bank_mask:0x2
    s_nop 0
    v_add_f32_dpp v59, v87, v59 row_ror:8 row_mask:0xf bank_mask:0x2
    v_add_f32_dpp v58, v72, v58 row_ror:8 row_mask:0xf bank_mask:0x4
    s_nop 0
    v_add_f32_dpp v59, v88, v59 row_ror:8 row_mask:0xf bank_mask:0x4
    v_add_f32_dpp v58, v77, v58 row_ror:8 row_mask:0xf bank_mask:0x8
    s_nop 0
    v_add_f32_dpp v59, v93, v59 row_ror:8 row_mask:0xf bank_mask:0x8
    v_add_f32_dpp v58, v65, v58 row_ror:12 row_mask:0xf bank_mask:0x1
    s_nop 0
    v_add_f32_dpp v59, v81, v59 row_ror:12 row_mask:0xf bank_mask:0x1
    v_add_f32_dpp v58, v70, v58 row_ror:12 row_mask:0xf bank_mask:0x2
    s_nop 0
    v_add_f32_dpp v59, v86, v59 row_ror:12 row_mask:0xf bank_mask:0x2
    v_add_f32_dpp v58, v75, v58 row_ror:12 row_mask:0xf bank_mask:0x4
    s_nop 0
    v_add_f32_dpp v59, v91, v59 row_ror:12 row_mask:0xf bank_mask:0x4
    v_add_f32_dpp v58, v76, v58 row_ror:12 row_mask:0xf bank_mask:0x8
    s_nop 0
    v_add_f32_dpp v59, v92, v59 row_ror:12 row_mask:0xf bank_mask:0x8
    v_cvt_pk_bf16_f32 v16, v58, v59
    v_lshlrev_b32 v58, 16, v16
    v_and_b32 v59, 0xffff0000, v16
    v_mul_f32 v58, s65, v58
    v_mul_f32 v59, s65, v59
    v_cvt_pk_bf16_f32 v16, v58, v59
    v_lshlrev_b32 v58, 16, v16
    v_and_b32 v59, 0xffff0000, v16
    s_cmp_ge_u32 s40, 9
    s_cbranch_scc1 L_nd86
    s_mov_b32 s88, 1600000
L_sw87:
    ds_read_b32 v22, v20 offset:32
    s_waitcnt lgkmcnt(0)
    v_readfirstlane_b32 s40, v22
    s_nop 0
    s_cmp_ge_u32 s40, 9
    s_cbranch_scc1 L_swok87
    s_sleep 1
    s_sub_u32 s88, s88, 1
    s_cbranch_scc0 L_sw87
L_swok87:
L_nd86:
    ds_read_b128 v[128:131], v2 offset:0
    ds_read_b128 v[132:135], v2 offset:1024
    ds_read_b128 v[136:139], v2 offset:2048
    ds_read_b128 v[140:143], v2 offset:3072
    v_mov_b32 v22, 9
    ds_write_b32 v20, v22 offset:64
    s_waitcnt lgkmcnt(0)
    v_mfma_f32_16x16x32_bf16 v[64:67], v[128:131], v[40:43], 0
    v_mfma_f32_16x16x32_bf16 v[68:71], v[128:131], v[44:47], 0
    v_mfma_f32_16x16x32_bf16 v[72:75], v[132:135], v[40:43], 0
    v_mfma_f32_16x16x32_bf16 v[76:79], v[132:135], v[44:47], 0
    v_mfma_f32_16x16x32_bf16 v[80:83], v[136:139], v[40:43], 0
    v_mfma_f32_16x16x32_bf16 v[84:87], v[136:139], v[44:47], 0
    v_mfma_f32_16x16x32_bf16 v[88:91], v[140:143], v[40:43], 0
    v_mfma_f32_16x16x32_bf16 v[92:95], v[140:143], v[44:47], 0
    s_nop 0
    v_add_f32_dpp v60, v67, v64 row_ror:4 row_mask:0xf bank_mask:0x1
    s_nop 2
    v_add_f32_dpp v61, v83, v80 row_ror:4 row_mask:0xf bank_mask:0x1
    v_add_f32_dpp v60, v68, v69 row_ror:4 row_mask:0xf bank_mask:0x2
    s_nop 0
    v_add_f32_dpp v61, v84, v85 row_ror:4 row_mask:0xf bank_mask:0x2
    v_add_f32_dpp v60, v73, v74 row_ror:4 row_mask:0xf bank_mask:0x4
    s_nop 0
    v_add_f32_dpp v61, v89, v90 row_ror:4 row_mask:0xf bank_mask:0x4
    v_add_f32_dpp v60, v78, v79 row_ror:4 row_mask:0xf bank_mask:0x8
    s_nop 0
    v_add_f32_dpp v61, v94, v95 row_ror:4 row_mask:0xf bank_mask:0x8
    v_add_f32_dpp v60, v66, v60 row_ror:8 row_mask:0xf bank_mask:0x1
    s_nop 0
    v_add_f32_dpp v61, v82, v61 row_ror:8 row_mask:0xf bank_mask:0x1
    v_add_f32_dpp v60, v71, v60 row_ror:8 row_mask:0xf bank_mask:0x2
    s_nop 0
    v_add_f32_dpp v61, v87, v61 row_ror:8 row_mask:0xf bank_mask:0x2
    v_add_f32_dpp v60, v72, v60 row_ror:8 row_mask:0xf bank_mask:0x4
    s_nop 0
    v_add_f32_dpp v61, v88, v61 row_ror:8 row_mask:0xf bank_mask:0x4
    v_add_f32_dpp v60, v77, v60 row_ror:8 row_mask:0xf bank_mask:0x8
    s_nop 0
    v_add_f32_dpp v61, v93, v61 row_ror:8 row_mask:0xf bank_mask:0x8
    v_add_f32_dpp v60, v65, v60 row_ror:12 row_mask:0xf bank_mask:0x1
    s_nop 0
    v_add_f32_dpp v61, v81, v61 row_ror:12 row_mask:0xf bank_mask:0x1
    v_add_f32_dpp v60, v70, v60 row_ror:12 row_mask:0xf bank_mask:0x2
    s_nop 0
    v_add_f32_dpp v61, v86, v61 row_ror:12 row_mask:0xf bank_mask:0x2
    v_add_f32_dpp v60, v75, v60 row_ror:12 row_mask:0xf bank_mask:0x4
    s_nop 0
    v_add_f32_dpp v61, v91, v61 row_ror:12 row_mask:0xf bank_mask:0x4
    v_add_f32_dpp v60, v76, v60 row_ror:12 row_mask:0xf bank_mask:0x8
    s_nop 0
    v_add_f32_dpp v61, v92, v61 row_ror:12 row_mask:0xf bank_mask:0x8
    v_cvt_pk_bf16_f32 v16, v60, v61
    v_lshlrev_b32 v60, 16, v16
    v_and_b32 v61, 0xffff0000, v16
    v_mul_f32 v60, s65, v60
    v_mul_f32 v61, s65, v61
    v_cvt_pk_bf16_f32 v16, v60, v61
    v_lshlrev_b32 v60, 16, v16
    v_and_b32 v61, 0xffff0000, v16
    s_cmp_ge_u32 s40, 10
    s_cbranch_scc1 L_nd88
    s_mov_b32 s88, 1600000
L_sw89:
    ds_read_b32 v22, v20 offset:32
    s_waitcnt lgkmcnt(0)
    v_readfirstlane_b32 s40, v22
    s_nop 0
    s_cmp_ge_u32 s40, 10
    s_cbranch_scc1 L_swok89
    s_sleep 1
    s_sub_u32 s88, s88, 1
    s_cbranch_scc0 L_sw89
L_swok89:
L_nd88:
    ds_read_b128 v[144:147], v2 offset:4096
    ds_read_b128 v[148:151], v2 offset:5120
    ds_read_b128 v[152:155], v2 offset:6144
    ds_read_b128 v[156:159], v2 offset:7168
    v_mov_b32 v22, 10
    ds_write_b32 v20, v22 offset:64
    s_waitcnt lgkmcnt(0)
    v_mfma_f32_16x16x32_bf16 v[64:67], v[144:147], v[40:43], 0
    v_mfma_f32_16x16x32_bf16 v[68:71], v[144:147], v[44:47], 0
    v_mfma_f32_16x16x32_bf16 v[72:75], v[148:151], v[40:43], 0
    v_mfma_f32_16x16x32_bf16 v[76:79], v[148:151], v[44:47], 0
    v_mfma_f32_16x16x32_bf16 v[80:83], v[152:155], v[40:43], 0
    v_mfma_f32_16x16x32_bf16 v[84:87], v[152:155], v[44:47], 0
    v_mfma_f32_16x16x32_bf16 v[88:91], v[156:159], v[40:43], 0
    v_mfma_f32_16x16x32_bf16 v[92:95], v[156:159], v[44:47], 0
    s_nop 0
    v_add_f32_dpp v62, v67, v64 row_ror:4 row_mask:0xf bank_mask:0x1
    s_nop 2
    v_add_f32_dpp v63, v83, v80 row_ror:4 row_mask:0xf bank_mask:0x1
    v_add_f32_dpp v62, v68, v69 row_ror:4 row_mask:0xf bank_mask:0x2
    s_nop 0
    v_add_f32_dpp v63, v84, v85 row_ror:4 row_mask:0xf bank_mask:0x2
    v_add_f32_dpp v62, v73, v74 row_ror:4 row_mask:0xf bank_mask:0x4
    s_nop 0
    v_add_f32_dpp v63, v89, v90 row_ror:4 row_mask:0xf bank_mask:0x4
    v_add_f32_dpp v62, v78, v79 row_ror:4 row_mask:0xf bank_mask:0x8
    s_nop 0
    v_add_f32_dpp v63, v94, v95 row_ror:4 row_mask:0xf bank_mask:0x8
    v_add_f32_dpp v62, v66, v62 row_ror:8 row_mask:0xf bank_mask:0x1
    s_nop 0
    v_add_f32_dpp v63, v82, v63 row_ror:8 row_mask:0xf bank_mask:0x1
    v_add_f32_dpp v62, v71, v62 row_ror:8 row_mask:0xf bank_mask:0x2
    s_nop 0
    v_add_f32_dpp v63, v87, v63 row_ror:8 row_mask:0xf bank_mask:0x2
    v_add_f32_dpp v62, v72, v62 row_ror:8 row_mask:0xf bank_mask:0x4
    s_nop 0
    v_add_f32_dpp v63, v88, v63 row_ror:8 row_mask:0xf bank_mask:0x4
    v_add_f32_dpp v62, v77, v62 row_ror:8 row_mask:0xf bank_mask:0x8
    s_nop 0
    v_add_f32_dpp v63, v93, v63 row_ror:8 row_mask:0xf bank_mask:0x8
    v_add_f32_dpp v62, v65, v62 row_ror:12 row_mask:0xf bank_mask:0x1
    s_nop 0
    v_add_f32_dpp v63, v81, v63 row_ror:12 row_mask:0xf bank_mask:0x1
    v_add_f32_dpp v62, v70, v62 row_ror:12 row_mask:0xf bank_mask:0x2
    s_nop 0
    v_add_f32_dpp v63, v86, v63 row_ror:12 row_mask:0xf bank_mask:0x2
    v_add_f32_dpp v62, v75, v62 row_ror:12 row_mask:0xf bank_mask:0x4
    s_nop 0
    v_add_f32_dpp v63, v91, v63 row_ror:12 row_mask:0xf bank_mask:0x4
    v_add_f32_dpp v62, v76, v62 row_ror:12 row_mask:0xf bank_mask:0x8
    s_nop 0
    v_add_f32_dpp v63, v92, v63 row_ror:12 row_mask:0xf bank_mask:0x8
    v_cvt_pk_bf16_f32 v16, v62, v63
    v_lshlrev_b32 v62, 16, v16
    v_and_b32 v63, 0xffff0000, v16
    v_mul_f32 v62, s65, v62
    v_mul_f32 v63, s65, v63
    v_cvt_pk_bf16_f32 v16, v62, v63
    v_lshlrev_b32 v62, 16, v16
    v_and_b32 v63, 0xffff0000, v16
    v_max3_f32 v16, v48, v49, v50
    v_max3_f32 v17, v51, v52, v53
    v_max3_f32 v18, v54, v55, v56
    v_max3_f32 v19, v57, v58, v59
    v_max3_f32 v16, v16, v60, v61
    v_max3_f32 v17, v17, v62, v63
    v_max3_f32 v16, v16, v17, v18
    v_max_f32 v5, v16, v19
    s_nop 1
    v_max_f32_dpp v5, v5, v5 row_ror:8 row_mask:0xf bank_mask:0xf
    v_mov_b32 v17, v5
    s_nop 1
    v_permlane16_swap_b32 v5, v17
    v_max_f32 v5, v5, v17
    v_mov_b32 v17, v5
    s_nop 1
    v_permlane32_swap_b32 v5, v17
    v_max_f32 v5, v5, v17
    v_sub_f32 v48, v48, v5
    v_sub_f32 v49, v49, v5
    v_sub_f32 v50, v50, v5
    v_sub_f32 v51, v51, v5
    v_sub_f32 v52, v52, v5
    v_sub_f32 v53, v53, v5
    v_sub_f32 v54, v54, v5
    v_sub_f32 v55, v55, v5
    v_sub_f32 v56, v56, v5
    v_sub_f32 v57, v57, v5
    v_sub_f32 v58, v58, v5
    v_sub_f32 v59, v59, v5
    v_sub_f32 v60, v60, v5
    v_sub_f32 v61, v61, v5
    v_sub_f32 v62, v62, v5
    v_sub_f32 v63, v63, v5
    v_mul_f32 v48, s66, v48
    v_mul_f32 v49, s66, v49
    v_mul_f32 v50, s66, v50
    v_mul_f32 v51, s66, v51
    v_mul_f32 v52, s66, v52
    v_mul_f32 v53, s66, v53
    v_mul_f32 v54, s66, v54
    v_mul_f32 v55, s66, v55
    v_mul_f32 v56, s66, v56
    v_mul_f32 v57, s66, v57
    v_mul_f32 v58, s66, v58
    v_mul_f32 v59, s66, v59
    v_mul_f32 v60, s66, v60
    v_mul_f32 v61, s66, v61
    v_mul_f32 v62, s66, v62
    v_mul_f32 v63, s66, v63
    v_exp_f32 v48, v48
    v_exp_f32 v49, v49
    v_exp_f32 v50, v50
    v_exp_f32 v51, v51
    v_exp_f32 v52, v52
    v_exp_f32 v53, v53
    v_exp_f32 v54, v54
    v_exp_f32 v55, v55
    v_exp_f32 v56, v56
    v_exp_f32 v57, v57
    v_exp_f32 v58, v58
    v_exp_f32 v59, v59
    v_exp_f32 v60, v60
    v_exp_f32 v61, v61
    v_exp_f32 v62, v62
    v_exp_f32 v63, v63
    v_pk_add_f32 v[16:17], v[48:49], v[50:51]
    v_pk_add_f32 v[18:19], v[52:53], v[54:55]
    v_pk_add_f32 v[16:17], v[16:17], v[56:57]
    v_pk_add_f32 v[18:19], v[18:19], v[58:59]
    v_pk_add_f32 v[16:17], v[16:17], v[60:61]
    v_pk_add_f32 v[18:19], v[18:19], v[62:63]
    v_pk_add_f32 v[16:17], v[16:17], v[18:19]
    v_add_f32 v16, v16, v17
    s_nop 1
    v_add_f32_dpp v16, v16, v16 row_ror:8 row_mask:0xf bank_mask:0xf
    v_mov_b32 v17, v16
    s_nop 1
    v_permlane16_swap_b32 v16, v17
    v_add_f32 v16, v16, v17
    v_mov_b32 v17, v16
    s_nop 1
    v_permlane32_swap_b32 v16, v17
    v_add_f32 v16, v16, v17
    v_and_b32 v11, 7, v1
    v_lshlrev_b32 v11, 5, v11
    s_lshl_b32 s59, s3, 2
    v_add_u32 v21, s59, v11
    s_mov_b64 exec, 0xff
    ds_write_b32 v21, v5 offset:4096
    ds_write_b32 v21, v16 offset:4352
    s_mov_b64 exec, -1
    v_mov_b32 v21, 8
    v_mov_b32 v22, 1
    s_mov_b64 exec, 1
    ds_add_rtn_u32 v22, v21, v22
    s_mov_b64 exec, -1
    s_waitcnt lgkmcnt(0)
    v_readfirstlane_b32 s59, v22
    s_nop 0
    s_cmp_eq_u32 s59, 7
    s_cbranch_scc0 L_skipml
    ds_read_b128 v[64:67], v11 offset:4096
    ds_read_b128 v[68:71], v11 offset:4112
    ds_read_b128 v[72:75], v11 offset:4352
    ds_read_b128 v[76:79], v11 offset:4368
    s_waitcnt lgkmcnt(2)
    v_max3_f32 v16, v64, v65, v66
    v_max3_f32 v17, v67, v68, v69
    v_max3_f32 v16, v16, v70, v71
    v_max_f32 v16, v16, v17
    v_sub_f32 v64, v64, v16
    v_sub_f32 v65, v65, v16
    v_sub_f32 v66, v66, v16
    v_sub_f32 v67, v67, v16
    v_sub_f32 v68, v68, v16
    v_sub_f32 v69, v69, v16
    v_sub_f32 v70, v70, v16
    v_sub_f32 v71, v71, v16
    v_mul_f32 v64, s66, v64
    v_mul_f32 v65, s66, v65
    v_mul_f32 v66, s66, v66
    v_mul_f32 v67, s66, v67
    v_mul_f32 v68, s66, v68
    v_mul_f32 v69, s66, v69
    v_mul_f32 v70, s66, v70
    v_mul_f32 v71, s66, v71
    v_exp_f32 v64, v64
    v_exp_f32 v65, v65
    v_exp_f32 v66, v66
    v_exp_f32 v67, v67
    v_exp_f32 v68, v68
    v_exp_f32 v69, v69
    v_exp_f32 v70, v70
    v_exp_f32 v71, v71
    s_waitcnt lgkmcnt(0)
    v_mul_f32 v18, v64, v72
    v_fmac_f32 v18, v65, v73
    v_fmac_f32 v18, v66, v74
    v_fmac_f32 v18, v67, v75
    v_fmac_f32 v18, v68, v76
    v_fmac_f32 v18, v69, v77
    v_fmac_f32 v18, v70, v78
    v_fmac_f32 v18, v71, v79
    v_mov_b32 v17, s60
    v_mov_b32 v19, s60
    v_lshlrev_b32 v21, 10, v1
    s_and_b32 s59, s2, 3
    s_lshl_b32 s70, s59, 13
    s_bfe_u32 s59, s2, 0x10002
    s_lshl_b32 s59, s59, 9
    s_add_u32 s70, s70, s59
    s_lshl_b32 s59, s57, 4
    s_add_u32 s70, s70, s59
    s_add_u32 s70, s70, 0x8000
    s_mov_b64 exec, 0xff
    buffer_store_dwordx4 v[16:19], v21, s[52:55], s70 offen sc1
    s_mov_b64 exec, -1
L_skipml:
    v_cvt_pk_bf16_f32 v48, v48, v48
    v_cvt_pk_bf16_f32 v49, v49, v49
    v_cvt_pk_bf16_f32 v50, v50, v50
    v_cvt_pk_bf16_f32 v51, v51, v51
    v_cvt_pk_bf16_f32 v52, v52, v52
    v_cvt_pk_bf16_f32 v53, v53, v53
    v_cvt_pk_bf16_f32 v54, v54, v54
    v_cvt_pk_bf16_f32 v55, v55, v55
    v_cvt_pk_bf16_f32 v56, v56, v56
    v_cvt_pk_bf16_f32 v57, v57, v57
    v_cvt_pk_bf16_f32 v58, v58, v58
    v_cvt_pk_bf16_f32 v59, v59, v59
    v_cvt_pk_bf16_f32 v60, v60, v60
    v_cvt_pk_bf16_f32 v61, v61, v61
    v_cvt_pk_bf16_f32 v62, v62, v62
    v_cvt_pk_bf16_f32 v63, v63, v63
    v_and_b32 v48, v48, v4
    v_and_b32 v49, v49, v4
    v_and_b32 v50, v50, v4
    v_and_b32 v51, v51, v4
    v_and_b32 v52, v52, v4
    v_and_b32 v53, v53, v4
    v_and_b32 v54, v54, v4
    v_and_b32 v55, v55, v4
    v_and_b32 v56, v56, v4
    v_and_b32 v57, v57, v4
    v_and_b32 v58, v58, v4
    v_and_b32 v59, v59, v4
    v_and_b32 v60, v60, v4
    v_and_b32 v61, v61, v4
    v_and_b32 v62, v62, v4
    v_and_b32 v63, v63, v4
    s_cmp_ge_u32 s3, 4
    s_cbranch_scc1 L_noh
    v_and_b32 v19, 15, v1
    v_lshlrev_b32 v19, 4, v19
    s_lshl_b32 s41, s57, 10
    s_lshl_b32 s59, s43, 8
    s_add_u32 s41, s41, s59
    s_add_u32 s41, s41, 0xc8000
    s_mov_b32 s88, 200000
L_mp90:
    buffer_load_dwordx4 v[40:43], v19, s[52:55], s41 offen sc1
    s_waitcnt vmcnt(0)
    v_min_u32 v16, v41, v43
    v_max_u32 v17, v41, v43
    v_cmp_ne_u32 vcc, s60, v16
    v_cmp_ne_u32 s[92:93], s60, v17
    s_nop 0
    s_or_b64 vcc, vcc, s[92:93]
    s_and_b64 exec, exec, vcc
    s_cbranch_scc0 L_mok90
    s_sleep 8
    s_sub_u32 s88, s88, 1
    s_cbranch_scc0 L_mp90
L_mok90:
    s_mov_b64 exec, -1
    s_mov_b32 vcc_lo, 0xffff0000
    s_mov_b32 vcc_hi, 0xffff0000
    v_cndmask_b32 v40, v40, v42, vcc
    v_and_b32 v16, 1, v1
    v_lshlrev_b32 v16, 6, v16
    v_lshrrev_b32 v17, 4, v1
    v_lshl_add_u32 v16, v17, 4, v16
    ds_bpermute_b32 v160, v16, v40 offset:0
    ds_bpermute_b32 v161, v16, v40 offset:4
    ds_bpermute_b32 v162, v16, v40 offset:8
    ds_bpermute_b32 v163, v16, v40 offset:12
L_noh:
    s_cmp_ge_u32 s40, 11
    s_cbranch_scc1 L_nd91
    s_mov_b32 s88, 1600000
L_sw92:
    ds_read_b32 v22, v20 offset:32
    s_waitcnt lgkmcnt(0)
    v_readfirstlane_b32 s40, v22
    s_nop 0
    s_cmp_ge_u32 s40, 11
    s_cbranch_scc1 L_swok92
    s_sleep 1
    s_sub_u32 s88, s88, 1
    s_cbranch_scc0 L_sw92
L_swok92:
L_nd91:
    ds_read_b128 v[96:99], v2 offset:8192
    ds_read_b128 v[100:103], v2 offset:9216
    ds_read_b128 v[104:107], v2 offset:10240
    ds_read_b128 v[108:111], v2 offset:11264
    v_mov_b32 v22, 11
    ds_write_b32 v20, v22 offset:64
    s_cmp_ge_u32 s40, 12
    s_cbranch_scc1 L_nd93
    s_mov_b32 s88, 1600000
L_sw94:
    ds_read_b32 v22, v20 offset:32
    s_waitcnt lgkmcnt(0)
    v_readfirstlane_b32 s40, v22
    s_nop 0
    s_cmp_ge_u32 s40, 12
    s_cbranch_scc1 L_swok94
    s_sleep 1
    s_sub_u32 s88, s88, 1
    s_cbranch_scc0 L_sw94
L_swok94:
L_nd93:
    ds_read_b128 v[112:115], v2 offset:12288
    ds_read_b128 v[116:119], v2 offset:13312
    ds_read_b128 v[120:123], v2 offset:14336
    ds_read_b128 v[124:127], v2 offset:15360
    v_mov_b32 v22, 12
    ds_write_b32 v20, v22 offset:64
    s_waitcnt lgkmcnt(0)
    v_perm_b32 v24, v100, v96, s63
    v_perm_b32 v25, v108, v104, s63
    v_perm_b32 v26, v116, v112, s63
    v_perm_b32 v27, v124, v120, s63
    v_perm_b32 v28, v100, v96, s64
    v_perm_b32 v29, v108, v104, s64
    v_perm_b32 v30, v116, v112, s64
    v_perm_b32 v31, v124, v120, s64
    v_perm_b32 v32, v101, v97, s63
    v_perm_b32 v33, v109, v105, s63
    v_perm_b32 v34, v117, v113, s63
    v_perm_b32 v35, v125, v121, s63
    v_perm_b32 v36, v101, v97, s64
    v_perm_b32 v37, v109, v105, s64
    v_perm_b32 v38, v117, v113, s64
    v_perm_b32 v39, v125, v121, s64
    v_mfma_f32_16x16x32_bf16 v[64:67], v[48:51], v[24:27], 0
    v_mfma_f32_16x16x32_bf16 v[68:71], v[48:51], v[28:31], 0
    v_mfma_f32_16x16x32_bf16 v[72:75], v[48:51], v[32:35], 0
    v_mfma_f32_16x16x32_bf16 v[76:79], v[48:51], v[36:39], 0
    v_perm_b32 v128, v102, v98, s63
    v_perm_b32 v129, v110, v106, s63
    v_perm_b32 v130, v118, v114, s63
    v_perm_b32 v131, v126, v122, s63
    v_perm_b32 v132, v102, v98, s64
    v_perm_b32 v133, v110, v106, s64
    v_perm_b32 v134, v118, v114, s64
    v_perm_b32 v135, v126, v122, s64
    v_perm_b32 v136, v103, v99, s63
    v_perm_b32 v137, v111, v107, s63
    v_perm_b32 v138, v119, v115, s63
    v_perm_b32 v139, v127, v123, s63
    v_perm_b32 v140, v103, v99, s64
    v_perm_b32 v141, v111, v107, s64
    v_perm_b32 v142, v119, v115, s64
    v_perm_b32 v143, v127, v123, s64
    v_mfma_f32_16x16x32_bf16 v[80:83], v[48:51], v[128:131], 0
    v_mfma_f32_16x16x32_bf16 v[84:87], v[48:51], v[132:135], 0
    v_mfma_f32_16x16x32_bf16 v[88:91], v[48:51], v[136:139], 0
    v_mfma_f32_16x16x32_bf16 v[92:95], v[48:51], v[140:143], 0
    v_mov_b32 v21, 0
    s_mov_b32 s88, 1600000
    s_nop 5
L_sw95:
    ds_read_b32 v22, v21 offset:8
    s_waitcnt lgkmcnt(0)
    v_readfirstlane_b32 s59, v22
    s_nop 0
    s_cmp_ge_u32 s59, 8
    s_cbranch_scc1 L_swok95
    s_sub_u32 s88, s88, 1
    s_cbranch_scc0 L_sw95
L_swok95:
    ds_read_b128 v[96:99], v11 offset:4096
    ds_read_b128 v[100:103], v11 offset:4112
    v_bfe_u32 v21, v1, 4, 1
    v_lshlrev_b32 v21, 4, v21
    s_waitcnt lgkmcnt(0)
    v_max3_f32 v16, v96, v97, v98
    v_max3_f32 v17, v99, v100, v101
    v_max3_f32 v16, v16, v102, v103
    v_max_f32 v16, v16, v17
    v_sub_f32 v5, v5, v16
    v_mul_f32 v5, s66, v5
    v_exp_f32 v5, v5
    s_nop 0
    ds_bpermute_b32 v6, v21, v5 offset:0
    ds_bpermute_b32 v7, v21, v5 offset:4
    ds_bpermute_b32 v8, v21, v5 offset:8
    ds_bpermute_b32 v9, v21, v5 offset:12
    s_cmp_ge_u32 s40, 13
    s_cbranch_scc1 L_nd96
    s_mov_b32 s88, 1600000
L_sw97:
    ds_read_b32 v22, v20 offset:32
    s_waitcnt lgkmcnt(0)
    v_readfirstlane_b32 s40, v22
    s_nop 0
    s_cmp_ge_u32 s40, 13
    s_cbranch_scc1 L_swok97
    s_sleep 1
    s_sub_u32 s88, s88, 1
    s_cbranch_scc0 L_sw97
L_swok97:
L_nd96:
    ds_read_b128 v[128:131], v2 offset:0
    ds_read_b128 v[132:135], v2 offset:1024
    ds_read_b128 v[136:139], v2 offset:2048
    ds_read_b128 v[140:143], v2 offset:3072
    v_mov_b32 v22, 13
    ds_write_b32 v20, v22 offset:64
    s_cmp_ge_u32 s40, 14
    s_cbranch_scc1 L_nd98
    s_mov_b32 s88, 1600000
L_sw99:
    ds_read_b32 v22, v20 offset:32
    s_waitcnt lgkmcnt(0)
    v_readfirstlane_b32 s40, v22
    s_nop 0
    s_cmp_ge_u32 s40, 14
    s_cbranch_scc1 L_swok99
    s_sleep 1
    s_sub_u32 s88, s88, 1
    s_cbranch_scc0 L_sw99
L_swok99:
L_nd98:
    ds_read_b128 v[144:147], v2 offset:4096
    ds_read_b128 v[148:151], v2 offset:5120
    ds_read_b128 v[152:155], v2 offset:6144
    ds_read_b128 v[156:159], v2 offset:7168
    v_mov_b32 v22, 14
    ds_write_b32 v20, v22 offset:64
    s_waitcnt lgkmcnt(0)
    v_perm_b32 v24, v132, v128, s63
    v_perm_b32 v25, v140, v136, s63
    v_perm_b32 v26, v148, v144, s63
    v_perm_b32 v27, v156, v152, s63
    v_perm_b32 v28, v132, v128, s64
    v_perm_b32 v29, v140, v136, s64
    v_perm_b32 v30, v148, v144, s64
    v_perm_b32 v31, v156, v152, s64
    v_perm_b32 v32, v133, v129, s63
    v_perm_b32 v33, v141, v137, s63
    v_perm_b32 v34, v149, v145, s63
    v_perm_b32 v35, v157, v153, s63
    v_perm_b32 v36, v133, v129, s64
    v_perm_b32 v37, v141, v137, s64
    v_perm_b32 v38, v149, v145, s64
    v_perm_b32 v39, v157, v153, s64
    v_mfma_f32_16x16x32_bf16 v[64:67], v[52:55], v[24:27], v[64:67]
    v_mfma_f32_16x16x32_bf16 v[68:71], v[52:55], v[28:31], v[68:71]
    v_mfma_f32_16x16x32_bf16 v[72:75], v[52:55], v[32:35], v[72:75]
    v_mfma_f32_16x16x32_bf16 v[76:79], v[52:55], v[36:39], v[76:79]
    v_perm_b32 v96, v134, v130, s63
    v_perm_b32 v97, v142, v138, s63
    v_perm_b32 v98, v150, v146, s63
    v_perm_b32 v99, v158, v154, s63
    v_perm_b32 v100, v134, v130, s64
    v_perm_b32 v101, v142, v138, s64
    v_perm_b32 v102, v150, v146, s64
    v_perm_b32 v103, v158, v154, s64
    v_perm_b32 v104, v135, v131, s63
    v_perm_b32 v105, v143, v139, s63
    v_perm_b32 v106, v151, v147, s63
    v_perm_b32 v107, v159, v155, s63
    v_perm_b32 v108, v135, v131, s64
    v_perm_b32 v109, v143, v139, s64
    v_perm_b32 v110, v151, v147, s64
    v_perm_b32 v111, v159, v155, s64
    v_mfma_f32_16x16x32_bf16 v[80:83], v[52:55], v[96:99], v[80:83]
    v_mfma_f32_16x16x32_bf16 v[84:87], v[52:55], v[100:103], v[84:87]
    v_mfma_f32_16x16x32_bf16 v[88:91], v[52:55], v[104:107], v[88:91]
    v_mfma_f32_16x16x32_bf16 v[92:95], v[52:55], v[108:111], v[92:95]
    s_cmp_lt_u32 s3, 4
    s_cbranch_scc1 L_noml
    s_lshr_b32 s41, s69, 2
    s_lshl_b32 s41, s41, 10
    s_add_u32 s41, s41, 0x8000
    s_mov_b32 s88, 200000
    s_nop 1
L_mp100:
    buffer_load_dwordx4 v[40:43], v3, s[52:55], s41 offen sc1
    s_waitcnt vmcnt(0)
    v_min_u32 v16, v41, v43
    v_max_u32 v17, v41, v43
    v_cmp_ne_u32 vcc, s60, v16
    v_cmp_ne_u32 s[92:93], s60, v17
    s_nop 0
    s_or_b64 vcc, vcc, s[92:93]
    s_and_b64 exec, exec, vcc
    s_cbranch_scc0 L_mok100
    s_sleep 8
    s_sub_u32 s88, s88, 1
    s_cbranch_scc0 L_mp100
L_mok100:
    s_mov_b64 exec, -1
    v_mov_b32 v16, v40
    s_nop 1
    v_max_f32_dpp v16, v16, v16 row_ror:8 row_mask:0xf bank_mask:0xf
    s_nop 1
    v_max_f32_dpp v16, v16, v16 row_ror:4 row_mask:0xf bank_mask:0xf
    s_nop 1
    v_max_f32_dpp v16, v16, v16 row_ror:2 row_mask:0xf bank_mask:0xf
    s_nop 1
    v_max_f32_dpp v16, v16, v16 row_ror:1 row_mask:0xf bank_mask:0xf
    v_mov_b32 v17, v16
    s_nop 1
    v_permlane16_swap_b32 v16, v17
    v_max_f32 v16, v16, v17
    v_sub_f32 v4, v40, v16
    v_mul_f32 v4, s66, v4
    v_exp_f32 v4, v4
    s_nop 0
    v_mul_f32 v16, v4, v42
    s_nop 1
    v_add_f32_dpp v16, v16, v16 row_ror:8 row_mask:0xf bank_mask:0xf
    s_nop 1
    v_add_f32_dpp v16, v16, v16 row_ror:4 row_mask:0xf bank_mask:0xf
    s_nop 1
    v_add_f32_dpp v16, v16, v16 row_ror:2 row_mask:0xf bank_mask:0xf
    s_nop 1
    v_add_f32_dpp v16, v16, v16 row_ror:1 row_mask:0xf bank_mask:0xf
    v_mov_b32 v17, v16
    s_nop 1
    v_permlane16_swap_b32 v16, v17
    v_add_f32 v16, v16, v17
    v_rcp_f32 v16, v16
    s_nop 0
    v_mul_f32 v4, v4, v16
    s_lshl_b32 s59, s43, 6
    v_lshrrev_b32 v16, 3, v1
    v_lshl_add_u32 v16, v16, 2, s59
    ds_bpermute_b32 v44, v16, v4
    ds_bpermute_b32 v45, v16, v4 offset:32
L_noml:
    s_cmp_ge_u32 s40, 15
    s_cbranch_scc1 L_nd101
    s_mov_b32 s88, 1600000
    s_nop 2
L_sw102:
    ds_read_b32 v22, v20 offset:32
    s_waitcnt lgkmcnt(0)
    v_readfirstlane_b32 s40, v22
    s_nop 0
    s_cmp_ge_u32 s40, 15
    s_cbranch_scc1 L_swok102
    s_sleep 1
    s_sub_u32 s88, s88, 1
    s_cbranch_scc0 L_sw102
L_swok102:
L_nd101:
    ds_read_b128 v[96:99], v2 offset:8192
    ds_read_b128 v[100:103], v2 offset:9216
    ds_read_b128 v[104:107], v2 offset:10240
    ds_read_b128 v[108:111], v2 offset:11264
    v_mov_b32 v22, 15
    ds_write_b32 v20, v22 offset:64
    s_cmp_ge_u32 s40, 16
    s_cbranch_scc1 L_nd103
    s_mov_b32 s88, 1600000
L_sw104:
    ds_read_b32 v22, v20 offset:32
    s_waitcnt lgkmcnt(0)
    v_readfirstlane_b32 s40, v22
    s_nop 0
    s_cmp_ge_u32 s40, 16
    s_cbranch_scc1 L_swok104
    s_sleep 1
    s_sub_u32 s88, s88, 1
    s_cbranch_scc0 L_sw104
L_swok104:
L_nd103:
    ds_read_b128 v[112:115], v2 offset:12288
    ds_read_b128 v[116:119], v2 offset:13312
    ds_read_b128 v[120:123], v2 offset:14336
    ds_read_b128 v[124:127], v2 offset:15360
    v_mov_b32 v22, 16
    ds_write_b32 v20, v22 offset:64
    s_waitcnt lgkmcnt(0)
    v_perm_b32 v24, v100, v96, s63
    v_perm_b32 v25, v108, v104, s63
    v_perm_b32 v26, v116, v112, s63
    v_perm_b32 v27, v124, v120, s63
    v_perm_b32 v28, v100, v96, s64
    v_perm_b32 v29, v108, v104, s64
    v_perm_b32 v30, v116, v112, s64
    v_perm_b32 v31, v124, v120, s64
    v_perm_b32 v32, v101, v97, s63
    v_perm_b32 v33, v109, v105, s63
    v_perm_b32 v34, v117, v113, s63
    v_perm_b32 v35, v125, v121, s63
    v_perm_b32 v36, v101, v97, s64
    v_perm_b32 v37, v109, v105, s64
    v_perm_b32 v38, v117, v113, s64
    v_perm_b32 v39, v125, v121, s64
    v_mfma_f32_16x16x32_bf16 v[64:67], v[56:59], v[24:27], v[64:67]
    v_mfma_f32_16x16x32_bf16 v[68:71], v[56:59], v[28:31], v[68:71]
    v_mfma_f32_16x16x32_bf16 v[72:75], v[56:59], v[32:35], v[72:75]
    v_mfma_f32_16x16x32_bf16 v[76:79], v[56:59], v[36:39], v[76:79]
    v_perm_b32 v128, v102, v98, s63
    v_perm_b32 v129, v110, v106, s63
    v_perm_b32 v130, v118, v114, s63
    v_perm_b32 v131, v126, v122, s63
    v_perm_b32 v132, v102, v98, s64
    v_perm_b32 v133, v110, v106, s64
    v_perm_b32 v134, v118, v114, s64
    v_perm_b32 v135, v126, v122, s64
    v_perm_b32 v136, v103, v99, s63
    v_perm_b32 v137, v111, v107, s63
    v_perm_b32 v138, v119, v115, s63
    v_perm_b32 v139, v127, v123, s63
    v_perm_b32 v140, v103, v99, s64
    v_perm_b32 v141, v111, v107, s64
    v_perm_b32 v142, v119, v115, s64
    v_perm_b32 v143, v127, v123, s64
    v_mfma_f32_16x16x32_bf16 v[80:83], v[56:59], v[128:131], v[80:83]
    v_mfma_f32_16x16x32_bf16 v[84:87], v[56:59], v[132:135], v[84:87]
    v_mfma_f32_16x16x32_bf16 v[88:91], v[56:59], v[136:139], v[88:91]
    v_mfma_f32_16x16x32_bf16 v[92:95], v[56:59], v[140:143], v[92:95]
    s_and_b32 s59, s57, 3
    s_cmp_eq_u32 s59, 0
    s_cselect_b32 s89, 1, 0
    s_lshr_b32 s59, s2, 5
    s_lshl_b32 s59, s59, 3
    s_add_u32 s90, s59, s56
    v_lshrrev_b32 v21, 3, v1
    v_and_b32 v16, 7, v1
    v_mul_u32_u24 v14, 8320, v21
    v_lshl_add_u32 v14, v16, 4, v14
    v_lshrrev_b32 v21, 4, v1
    v_lshl_add_u32 v13, v16, 2, v21
    v_lshlrev_b32 v13, 4, v13
    s_lshl_b32 s59, s43, 2
    v_add_u32 v13, s59, v13
    s_lshl_b32 s56, s90, 7
    s_mul_i32 s59, s43, 66560
    s_add_u32 s62, s56, s59
    s_add_u32 s62, s62, 0x240000
    s_mul_i32 s59, s43, 266240
    s_add_u32 s56, s56, s59
    s_add_u32 s56, s56, 0x400000
    v_and_b32 v16, 1, v1
    v_lshlrev_b32 v16, 11, v16
    v_bfe_u32 v17, v1, 1, 4
    v_lshl_add_u32 v16, v17, 1, v16
    s_lshl_b32 s59, s90, 5
    v_add_u32 v12, s59, v16
    global_load_ushort v10, v12, s[4:5]
    v_bfe_u32 v11, v1, 4, 1
    v_lshlrev_b32 v11, 11, v11
    v_and_b32 v16, 15, v1
    v_lshl_add_u32 v11, v16, 5, v11
    v_lshrrev_b32 v17, 5, v1
    v_lshl_add_u32 v11, v17, 4, v11
    s_lshl_b32 s59, s3, 14
    v_add_u32 v11, s59, v11
    s_lshl_b32 s59, s43, 10
    v_add_u32 v5, s59, v3
    v_add_u32 v164, 0x14000, v5
    v_add_u32 v165, 0x4000, v5
    s_and_b32 s59, s2, 3
    s_mul_i32 s70, s59, 266240
    s_mul_i32 s59, s43, 66560
    s_add_u32 s70, s70, s59
    s_bfe_u32 s59, s2, 0x10002
    s_lshl_b32 s59, s59, 12
    s_add_u32 s70, s70, s59
    s_lshl_b32 s59, s57, 7
    s_add_u32 s70, s70, s59
    s_add_u32 s70, s70, 0x100000
    s_mul_i32 s71, s69, 8320
    s_lshl_b32 s59, s43, 11
    s_add_u32 s71, s71, s59
    s_add_u32 s71, s71, 0x100000
    v_and_b32 v16, 7, v1
    v_lshlrev_b32 v18, 4, v16
    v_lshrrev_b32 v17, 4, v1
    v_lshl_add_u32 v18, v17, 2, v18
    s_lshl_b32 s59, s43, 7
    v_add_u32 v18, s59, v18
    v_and_b32 v16, 1, v1
    v_lshlrev_b32 v19, 8, v16
    v_lshl_add_u32 v19, v17, 5, v19
    s_mul_i32 s91, s69, 8320
    s_lshr_b32 s59, s2, 7
    s_lshl_b32 s59, s59, 12
    s_add_u32 s91, s91, s59
    s_lshl_b32 s59, s43, 10
    s_add_u32 s91, s91, s59
    s_add_u32 s91, s91, 0x400000
    s_mul_i32 s57, s57, 8320
    s_lshl_b32 s59, s42, 10
    s_add_u32 s57, s57, s59
    s_add_u32 s57, s57, 0x240000
    s_cmp_ge_u32 s40, 17
    s_cbranch_scc1 L_nd105
    s_mov_b32 s88, 1600000
L_sw106:
    ds_read_b32 v22, v20 offset:32
    s_waitcnt lgkmcnt(0)
    v_readfirstlane_b32 s40, v22
    s_nop 0
    s_cmp_ge_u32 s40, 17
    s_cbranch_scc1 L_swok106
    s_sleep 1
    s_sub_u32 s88, s88, 1
    s_cbranch_scc0 L_sw106
L_swok106:
L_nd105:
    ds_read_b128 v[128:131], v2 offset:0
    ds_read_b128 v[132:135], v2 offset:1024
    ds_read_b128 v[136:139], v2 offset:2048
    ds_read_b128 v[140:143], v2 offset:3072
    s_cmp_ge_u32 s40, 18
    s_cbranch_scc1 L_nd107
    s_mov_b32 s88, 1600000
L_sw108:
    ds_read_b32 v22, v20 offset:32
    s_waitcnt lgkmcnt(0)
    v_readfirstlane_b32 s40, v22
    s_nop 0
    s_cmp_ge_u32 s40, 18
    s_cbranch_scc1 L_swok108
    s_sub_u32 s88, s88, 1
    s_cbranch_scc0 L_sw108
L_swok108:
L_nd107:
    ds_read_b128 v[144:147], v2 offset:4096
    ds_read_b128 v[148:151], v2 offset:5120
    ds_read_b128 v[152:155], v2 offset:6144
    ds_read_b128 v[156:159], v2 offset:7168
    s_waitcnt lgkmcnt(0)
    v_perm_b32 v24, v132, v128, s63
    v_perm_b32 v25, v140, v136, s63
    v_perm_b32 v26, v148, v144, s63
    v_perm_b32 v27, v156, v152, s63
    v_perm_b32 v28, v132, v128, s64
    v_perm_b32 v29, v140, v136, s64
    v_perm_b32 v30, v148, v144, s64
    v_perm_b32 v31, v156, v152, s64
    v_perm_b32 v32, v133, v129, s63
    v_perm_b32 v33, v141, v137, s63
    v_perm_b32 v34, v149, v145, s63
    v_perm_b32 v35, v157, v153, s63
    v_perm_b32 v36, v133, v129, s64
    v_perm_b32 v37, v141, v137, s64
    v_perm_b32 v38, v149, v145, s64
    v_perm_b32 v39, v157, v153, s64
    v_mfma_f32_16x16x32_bf16 v[64:67], v[60:63], v[24:27], v[64:67]
    v_mfma_f32_16x16x32_bf16 v[68:71], v[60:63], v[28:31], v[68:71]
    v_mfma_f32_16x16x32_bf16 v[72:75], v[60:63], v[32:35], v[72:75]
    v_mfma_f32_16x16x32_bf16 v[76:79], v[60:63], v[36:39], v[76:79]
    v_perm_b32 v96, v134, v130, s63
    v_perm_b32 v97, v142, v138, s63
    v_perm_b32 v98, v150, v146, s63
    v_perm_b32 v99, v158, v154, s63
    v_perm_b32 v100, v134, v130, s64
    v_perm_b32 v101, v142, v138, s64
    v_perm_b32 v102, v150, v146, s64
    v_perm_b32 v103, v158, v154, s64
    v_perm_b32 v104, v135, v131, s63
    v_perm_b32 v105, v143, v139, s63
    v_perm_b32 v106, v151, v147, s63
    v_perm_b32 v107, v159, v155, s63
    v_perm_b32 v108, v135, v131, s64
    v_perm_b32 v109, v143, v139, s64
    v_perm_b32 v110, v151, v147, s64
    v_perm_b32 v111, v159, v155, s64
    v_mfma_f32_16x16x32_bf16 v[80:83], v[60:63], v[96:99], v[80:83]
    v_mfma_f32_16x16x32_bf16 v[84:87], v[60:63], v[100:103], v[84:87]
    v_mfma_f32_16x16x32_bf16 v[88:91], v[60:63], v[104:107], v[88:91]
    v_mfma_f32_16x16x32_bf16 v[92:95], v[60:63], v[108:111], v[92:95]
    s_nop 4
    v_permlane32_swap_b32 v64, v80
    v_permlane32_swap_b32 v68, v84
    v_permlane32_swap_b32 v72, v88
    v_permlane32_swap_b32 v76, v92
    v_permlane32_swap_b32 v65, v81
    v_permlane32_swap_b32 v69, v85
    v_permlane32_swap_b32 v73, v89
    v_permlane32_swap_b32 v77, v93
    v_permlane32_swap_b32 v66, v82
    v_permlane32_swap_b32 v70, v86
    v_permlane32_swap_b32 v74, v90
    v_permlane32_swap_b32 v78, v94
    v_permlane32_swap_b32 v67, v83
    v_permlane32_swap_b32 v71, v87
    v_permlane32_swap_b32 v75, v91
    v_permlane32_swap_b32 v79, v95
    v_add_f32 v128, v64, v80
    v_add_f32 v129, v68, v84
    v_add_f32 v130, v72, v88
    v_add_f32 v131, v76, v92
    v_mul_f32 v128, v6, v128
    v_mul_f32 v129, v6, v129
    v_mul_f32 v130, v6, v130
    v_mul_f32 v131, v6, v131
    ds_write_b128 v11, v[128:131] offset:16384
    v_add_f32 v132, v65, v81
    v_add_f32 v133, v69, v85
    v_add_f32 v134, v73, v89
    v_add_f32 v135, v77, v93
    v_mul_f32 v132, v7, v132
    v_mul_f32 v133, v7, v133
    v_mul_f32 v134, v7, v134
    v_mul_f32 v135, v7, v135
    ds_write_b128 v11, v[132:135] offset:16896
    v_add_f32 v136, v66, v82
    v_add_f32 v137, v70, v86
    v_add_f32 v138, v74, v90
    v_add_f32 v139, v78, v94
    v_mul_f32 v136, v8, v136
    v_mul_f32 v137, v8, v137
    v_mul_f32 v138, v8, v138
    v_mul_f32 v139, v8, v139
    ds_write_b128 v11, v[136:139] offset:17408
    v_add_f32 v140, v67, v83
    v_add_f32 v141, v71, v87
    v_add_f32 v142, v75, v91
    v_add_f32 v143, v79, v95
    v_mul_f32 v140, v9, v140
    v_mul_f32 v141, v9, v141
    v_mul_f32 v142, v9, v142
    v_mul_f32 v143, v9, v143
    ds_write_b128 v11, v[140:143] offset:17920
    v_mov_b32 v21, 28
    v_mov_b32 v22, 1
    s_mov_b64 exec, 1
    ds_add_u32 v21, v22
    s_mov_b64 exec, -1
    s_cmp_ge_u32 s3, 4
    s_cbranch_scc1 L_hi
    v_mov_b32 v21, 0
    s_mov_b32 s88, 1600000
    s_nop 0
L_sw109:
    ds_read_b32 v22, v21 offset:28
    s_waitcnt lgkmcnt(0)
    v_readfirstlane_b32 s59, v22
    s_nop 0
    s_cmp_ge_u32 s59, 8
    s_cbranch_scc1 L_swok109
    s_sub_u32 s88, s88, 1
    s_cbranch_scc0 L_sw109
L_swok109:
    ds_read_b128 v[64:67], v165 offset:0
    ds_read_b128 v[68:71], v165 offset:16384
    ds_read_b128 v[72:75], v165 offset:32768
    ds_read_b128 v[76:79], v165 offset:49152
    ds_read_b128 v[80:83], v164 offset:0
    ds_read_b128 v[84:87], v164 offset:16384
    ds_read_b128 v[88:91], v164 offset:32768
    ds_read_b128 v[92:95], v164 offset:49152
    s_waitcnt lgkmcnt(6)
    v_pk_add_f32 v[64:65], v[64:65], v[68:69]
    v_pk_add_f32 v[66:67], v[66:67], v[70:71]
    s_waitcnt lgkmcnt(4)
    v_pk_add_f32 v[72:73], v[72:73], v[76:77]
    v_pk_add_f32 v[74:75], v[74:75], v[78:79]
    s_waitcnt lgkmcnt(2)
    v_pk_add_f32 v[80:81], v[80:81], v[84:85]
    v_pk_add_f32 v[82:83], v[82:83], v[86:87]
    s_waitcnt lgkmcnt(0)
    v_pk_add_f32 v[88:89], v[88:89], v[92:93]
    v_pk_add_f32 v[90:91], v[90:91], v[94:95]
    v_pk_add_f32 v[64:65], v[64:65], v[72:73]
    v_pk_add_f32 v[66:67], v[66:67], v[74:75]
    v_pk_add_f32 v[80:81], v[80:81], v[88:89]
    v_pk_add_f32 v[82:83], v[82:83], v[90:91]
    v_pk_add_f32 v[64:65], v[64:65], v[80:81]
    v_pk_add_f32 v[66:67], v[66:67], v[82:83]
    v_add_u32 v64, 0x800, v64
    v_add_u32 v65, 0x800, v65
    v_add_u32 v66, 0x800, v66
    v_add_u32 v67, 0x800, v67
    v_mov_b32 v21, s61
    v_and_or_b32 v64, v64, s67, v21
    v_and_or_b32 v65, v65, s67, v21
    v_and_or_b32 v66, v66, s67, v21
    v_and_or_b32 v67, v67, s67, v21
    buffer_store_dwordx4 v[64:67], v14, s[52:55], s70 offen sc1
    s_cmp_ge_u32 s40, 19
    s_cbranch_scc1 L_nd110
    s_mov_b32 s88, 1600000
L_sw111:
    ds_read_b32 v22, v20 offset:32
    s_waitcnt lgkmcnt(0)
    v_readfirstlane_b32 s40, v22
    s_nop 0
    s_cmp_ge_u32 s40, 19
    s_cbranch_scc1 L_swok111
    s_sub_u32 s88, s88, 1
    s_cbranch_scc0 L_sw111
L_swok111:
L_nd110:
    ds_read_b128 v[96:99], v2 offset:8192
    ds_read_b128 v[100:103], v2 offset:9216
    ds_read_b128 v[104:107], v2 offset:10240
    ds_read_b128 v[108:111], v2 offset:11264
    s_cmp_ge_u32 s40, 20
    s_cbranch_scc1 L_nd112
    s_mov_b32 s88, 1600000
L_sw113:
    ds_read_b32 v22, v20 offset:32
    s_waitcnt lgkmcnt(0)
    v_readfirstlane_b32 s40, v22
    s_nop 0
    s_cmp_ge_u32 s40, 20
    s_cbranch_scc1 L_swok113
    s_sub_u32 s88, s88, 1
    s_cbranch_scc0 L_sw113
L_swok113:
L_nd112:
    ds_read_b128 v[112:115], v2 offset:12288
    ds_read_b128 v[116:119], v2 offset:13312
    ds_read_b128 v[120:123], v2 offset:14336
    ds_read_b128 v[124:127], v2 offset:15360
    v_cndmask_b32 v64, 0, v160, s[72:73]
    v_cndmask_b32 v65, 0, v161, s[72:73]
    v_cndmask_b32 v66, 0, v162, s[72:73]
    v_cndmask_b32 v67, 0, v163, s[72:73]
    v_cndmask_b32 v68, 0, v160, s[74:75]
    v_cndmask_b32 v69, 0, v161, s[74:75]
    v_cndmask_b32 v70, 0, v162, s[74:75]
    v_cndmask_b32 v71, 0, v163, s[74:75]
    v_cndmask_b32 v72, 0, v160, s[76:77]
    v_cndmask_b32 v73, 0, v161, s[76:77]
    v_cndmask_b32 v74, 0, v162, s[76:77]
    v_cndmask_b32 v75, 0, v163, s[76:77]
    v_cndmask_b32 v76, 0, v160, s[78:79]
    v_cndmask_b32 v77, 0, v161, s[78:79]
    v_cndmask_b32 v78, 0, v162, s[78:79]
    v_cndmask_b32 v79, 0, v163, s[78:79]
    v_cndmask_b32 v80, 0, v160, s[80:81]
    v_cndmask_b32 v81, 0, v161, s[80:81]
    v_cndmask_b32 v82, 0, v162, s[80:81]
    v_cndmask_b32 v83, 0, v163, s[80:81]
    v_cndmask_b32 v84, 0, v160, s[82:83]
    v_cndmask_b32 v85, 0, v161, s[82:83]
    v_cndmask_b32 v86, 0, v162, s[82:83]
    v_cndmask_b32 v87, 0, v163, s[82:83]
    v_cndmask_b32 v88, 0, v160, s[84:85]
    v_cndmask_b32 v89, 0, v161, s[84:85]
    v_cndmask_b32 v90, 0, v162, s[84:85]
    v_cndmask_b32 v91, 0, v163, s[84:85]
    v_cndmask_b32 v92, 0, v160, s[86:87]
    v_cndmask_b32 v93, 0, v161, s[86:87]
    v_cndmask_b32 v94, 0, v162, s[86:87]
    v_cndmask_b32 v95, 0, v163, s[86:87]
    s_waitcnt lgkmcnt(0)
    v_perm_b32 v128, v100, v96, s63
    v_perm_b32 v129, v108, v104, s63
    v_perm_b32 v130, v116, v112, s63
    v_perm_b32 v131, v124, v120, s63
    v_perm_b32 v132, v100, v96, s64
    v_perm_b32 v133, v108, v104, s64
    v_perm_b32 v134, v116, v112, s64
    v_perm_b32 v135, v124, v120, s64
    v_perm_b32 v136, v101, v97, s63
    v_perm_b32 v137, v109, v105, s63
    v_perm_b32 v138, v117, v113, s63
    v_perm_b32 v139, v125, v121, s63
    v_perm_b32 v140, v101, v97, s64
    v_perm_b32 v141, v109, v105, s64
    v_perm_b32 v142, v117, v113, s64
    v_perm_b32 v143, v125, v121, s64
    v_perm_b32 v144, v102, v98, s63
    v_perm_b32 v145, v110, v106, s63
    v_perm_b32 v146, v118, v114, s63
    v_perm_b32 v147, v126, v122, s63
    v_perm_b32 v148, v102, v98, s64
    v_perm_b32 v149, v110, v106, s64
    v_perm_b32 v150, v118, v114, s64
    v_perm_b32 v151, v126, v122, s64
    v_perm_b32 v152, v103, v99, s63
    v_perm_b32 v153, v111, v107, s63
    v_perm_b32 v154, v119, v115, s63
    v_perm_b32 v155, v127, v123, s63
    v_perm_b32 v156, v103, v99, s64
    v_perm_b32 v157, v111, v107, s64
    v_perm_b32 v158, v119, v115, s64
    v_perm_b32 v159, v127, v123, s64
    v_mfma_f32_16x16x32_bf16 v[48:51], v[64:67], v[128:131], 0
    v_mfma_f32_16x16x32_bf16 v[48:51], v[68:71], v[132:135], v[48:51]
    v_mfma_f32_16x16x32_bf16 v[48:51], v[72:75], v[136:139], v[48:51]
    v_mfma_f32_16x16x32_bf16 v[48:51], v[76:79], v[140:143], v[48:51]
    v_mfma_f32_16x16x32_bf16 v[48:51], v[80:83], v[144:147], v[48:51]
    v_mfma_f32_16x16x32_bf16 v[48:51], v[84:87], v[148:151], v[48:51]
    v_mfma_f32_16x16x32_bf16 v[48:51], v[88:91], v[152:155], v[48:51]
    v_mfma_f32_16x16x32_bf16 v[48:51], v[92:95], v[156:159], v[48:51]
    s_nop 7
    ds_write_b128 v5, v[48:51] offset:8192
    v_mov_b32 v21, 12
    v_mov_b32 v22, 1
    s_mov_b64 exec, 1
    ds_add_rtn_u32 v22, v21, v22
    s_mov_b64 exec, -1
    s_waitcnt lgkmcnt(0)
    v_readfirstlane_b32 s59, v22
    s_nop 0
    s_cmp_eq_u32 s59, 3
    s_cbranch_scc0 L_skipf
    ds_read_b128 v[96:99], v3 offset:8192
    ds_read_b128 v[100:103], v3 offset:9216
    ds_read_b128 v[104:107], v3 offset:10240
    ds_read_b128 v[108:111], v3 offset:11264
    s_add_u32 s59, s57, 266240
    s_waitcnt lgkmcnt(2)
    v_pk_add_f32 v[96:97], v[96:97], v[100:101]
    v_pk_add_f32 v[98:99], v[98:99], v[102:103]
    s_waitcnt lgkmcnt(0)
    v_pk_add_f32 v[104:105], v[104:105], v[108:109]
    v_pk_add_f32 v[106:107], v[106:107], v[110:111]
    v_pk_add_f32 v[96:97], v[96:97], v[104:105]
    v_pk_add_f32 v[98:99], v[98:99], v[106:107]
    v_mov_b32 v100, v97
    v_mov_b32 v102, v99
    v_mov_b32 v97, s60
    v_mov_b32 v99, s60
    v_mov_b32 v101, s60
    v_mov_b32 v103, s60
    buffer_store_dwordx4 v[96:99], v15, s[52:55], s57 offen sc1
    buffer_store_dwordx4 v[100:103], v15, s[52:55], s59 offen sc1
L_skipf:
    s_cmp_eq_u32 s89, 0
    s_cbranch_scc1 L_fin
    s_mov_b32 s88, 200000
L_mp114:
    buffer_load_dwordx4 v[56:59], v14, s[52:55], s62 offen sc1
    s_add_u32 s59, s62, 266240
    buffer_load_dwordx4 v[60:63], v14, s[52:55], s59 offen sc1
    s_waitcnt vmcnt(0)
    v_min3_u32 v16, v57, v59, v61
    v_min_u32 v16, v16, v63
    v_max3_u32 v17, v57, v59, v61
    v_max_u32 v17, v17, v63
    v_cmp_ne_u32 vcc, s60, v16
    v_cmp_ne_u32 s[92:93], s60, v17
    s_nop 0
    s_or_b64 vcc, vcc, s[92:93]
    s_and_b64 exec, exec, vcc
    s_cbranch_scc0 L_mok114
    s_bcnt1_i32_b64 s59, exec
    s_cmp_lt_u32 s59, 32
    s_cbranch_scc1 L_mn114
    s_sleep 8
L_mn114:
    s_sub_u32 s88, s88, 1
    s_cbranch_scc0 L_mp114
L_mok114:
    s_mov_b64 exec, -1
    s_mov_b32 s88, 200000
L_mp115:
    s_add_u32 s59, s56, 0
    buffer_load_dwordx4 v[24:27], v14, s[52:55], s59 offen sc1
    s_add_u32 s59, s56, 66560
    buffer_load_dwordx4 v[28:31], v14, s[52:55], s59 offen sc1
    s_add_u32 s59, s56, 133120
    buffer_load_dwordx4 v[32:35], v14, s[52:55], s59 offen sc1
    s_add_u32 s59, s56, 199680
    buffer_load_dwordx4 v[36:39], v14, s[52:55], s59 offen sc1
    s_waitcnt vmcnt(0)
    v_xor_b32 v24, s61, v24
    v_xor_b32 v25, s61, v25
    v_xor_b32 v26, s61, v26
    v_xor_b32 v27, s61, v27
    v_xor_b32 v28, s61, v28
    v_xor_b32 v29, s61, v29
    v_xor_b32 v30, s61, v30
    v_xor_b32 v31, s61, v31
    v_xor_b32 v32, s61, v32
    v_xor_b32 v33, s61, v33
    v_xor_b32 v34, s61, v34
    v_xor_b32 v35, s61, v35
    v_xor_b32 v36, s61, v36
    v_xor_b32 v37, s61, v37
    v_xor_b32 v38, s61, v38
    v_xor_b32 v39, s61, v39
    v_or3_b32 v16, v24, v25, v26
    v_or3_b32 v16, v16, v27, v28
    v_or3_b32 v16, v16, v29, v30
    v_or3_b32 v16, v16, v31, v32
    v_or3_b32 v16, v16, v33, v34
    v_or3_b32 v16, v16, v35, v36
    v_or3_b32 v16, v16, v37, v38
    v_or_b32 v16, v16, v39
    v_and_b32 v16, 0xfff, v16
    v_cmp_ne_u32 vcc, 0, v16
    s_nop 0
    s_and_b64 exec, exec, vcc
    s_cbranch_scc0 L_mok115
    s_sub_u32 s88, s88, 1
    s_cbranch_scc0 L_mp115
L_mok115:
    s_mov_b64 exec, -1
    v_pk_add_f32 v[24:25], v[24:25], v[28:29]
    v_pk_add_f32 v[26:27], v[26:27], v[30:31]
    v_pk_add_f32 v[32:33], v[32:33], v[36:37]
    v_pk_add_f32 v[34:35], v[34:35], v[38:39]
    v_pk_add_f32 v[24:25], v[24:25], v[32:33]
    v_pk_add_f32 v[26:27], v[26:27], v[34:35]
    v_mov_b32 v57, v60
    v_mov_b32 v59, v62
    v_permlane32_swap_b32 v24, v26
    v_permlane32_swap_b32 v25, v27
    v_permlane32_swap_b32 v56, v58
    v_permlane32_swap_b32 v57, v59
    v_pk_add_f32 v[24:25], v[24:25], v[26:27]
    v_pk_add_f32 v[56:57], v[56:57], v[58:59]
    s_nop 0
    v_permlane16_swap_b32 v24, v25
    v_permlane16_swap_b32 v56, v57
    v_add_f32 v24, v24, v25
    v_add_f32 v56, v56, v57
    s_nop 0
    v_add_f32_dpp v24, v24, v24 row_ror:8 row_mask:0xf bank_mask:0xf
    v_add_f32_dpp v56, v56, v56 row_ror:8 row_mask:0xf bank_mask:0xf
    ds_write_b32 v13, v24 offset:5632
    ds_write_b32 v13, v56 offset:5120
    v_and_b32 v16, 31, v1
    v_lshlrev_b32 v16, 4, v16
    v_mov_b32 v21, 20
    v_mov_b32 v22, 1
    s_mov_b64 exec, 1
    ds_add_rtn_u32 v22, v21, v22
    s_mov_b64 exec, -1
    s_waitcnt lgkmcnt(0)
    v_readfirstlane_b32 s59, v22
    s_nop 0
    s_cmp_eq_u32 s59, 3
    s_cbranch_scc0 L_fin
    ds_read_b128 v[24:27], v16 offset:5632
    ds_read_b128 v[32:35], v16 offset:5120
    v_lshlrev_b32 v10, 16, v10
    s_waitcnt lgkmcnt(0)
    v_pk_add_f32 v[24:25], v[24:25], v[26:27]
    v_pk_add_f32 v[32:33], v[32:33], v[34:35]
    v_add_f32 v24, v24, v25
    v_add_f32 v32, v32, v33
    v_cvt_pk_bf16_f32 v16, v24, v32
    v_lshlrev_b32 v24, 16, v16
    v_and_b32 v32, 0xffff0000, v16
    v_add_f32 v24, v24, v10
    v_cvt_pk_bf16_f32 v16, v24, v24
    v_and_b32 v16, 0xffff0000, v16
    v_add_f32 v16, v16, v32
    v_cvt_pk_bf16_f32 v16, v16, v16
    s_mov_b32 exec_hi, 0
    global_store_short v12, v16, s[20:21]
    s_cmp_lg_u32 s2, 0
    s_cbranch_scc1 L_noep
    v_mov_b32 v21, 0
    v_mov_b32 v22, s60
    s_mov_b64 exec, 1
    buffer_store_dword v22, v21, s[52:55], 0 offen sc1
L_noep:
    s_mov_b64 exec, -1
    s_branch L_fin
L_hi:
    buffer_load_dwordx4 v[24:27], v3, s[52:55], s71 offen offset:0 sc1
    buffer_load_dwordx4 v[28:31], v3, s[52:55], s71 offen offset:1024 sc1
    s_cmp_ge_u32 s40, 19
    s_cbranch_scc1 L_nd116
    s_mov_b32 s88, 1600000
L_sw117:
    ds_read_b32 v22, v20 offset:32
    s_waitcnt lgkmcnt(0)
    v_readfirstlane_b32 s40, v22
    s_nop 0
    s_cmp_ge_u32 s40, 19
    s_cbranch_scc1 L_swok117
    s_sub_u32 s88, s88, 1
    s_cbranch_scc0 L_sw117
L_swok117:
L_nd116:
    ds_read_b128 v[96:99], v2 offset:8192
    ds_read_b128 v[100:103], v2 offset:9216
    ds_read_b128 v[104:107], v2 offset:10240
    ds_read_b128 v[108:111], v2 offset:11264
    s_cmp_ge_u32 s40, 20
    s_cbranch_scc1 L_nd118
    s_mov_b32 s88, 1600000
L_sw119:
    ds_read_b32 v22, v20 offset:32
    s_waitcnt lgkmcnt(0)
    v_readfirstlane_b32 s40, v22
    s_nop 0
    s_cmp_ge_u32 s40, 20
    s_cbranch_scc1 L_swok119
    s_sub_u32 s88, s88, 1
    s_cbranch_scc0 L_sw119
L_swok119:
L_nd118:
    ds_read_b128 v[112:115], v2 offset:12288
    ds_read_b128 v[116:119], v2 offset:13312
    ds_read_b128 v[120:123], v2 offset:14336
    ds_read_b128 v[124:127], v2 offset:15360
    s_waitcnt lgkmcnt(0)
    v_perm_b32 v128, v100, v96, s63
    v_perm_b32 v129, v108, v104, s63
    v_perm_b32 v130, v116, v112, s63
    v_perm_b32 v131, v124, v120, s63
    v_perm_b32 v132, v100, v96, s64
    v_perm_b32 v133, v108, v104, s64
    v_perm_b32 v134, v116, v112, s64
    v_perm_b32 v135, v124, v120, s64
    v_perm_b32 v136, v101, v97, s63
    v_perm_b32 v137, v109, v105, s63
    v_perm_b32 v138, v117, v113, s63
    v_perm_b32 v139, v125, v121, s63
    v_perm_b32 v140, v101, v97, s64
    v_perm_b32 v141, v109, v105, s64
    v_perm_b32 v142, v117, v113, s64
    v_perm_b32 v143, v125, v121, s64
    v_perm_b32 v144, v102, v98, s63
    v_perm_b32 v145, v110, v106, s63
    v_perm_b32 v146, v118, v114, s63
    v_perm_b32 v147, v126, v122, s63
    v_perm_b32 v148, v102, v98, s64
    v_perm_b32 v149, v110, v106, s64
    v_perm_b32 v150, v118, v114, s64
    v_perm_b32 v151, v126, v122, s64
    v_perm_b32 v152, v103, v99, s63
    v_perm_b32 v153, v111, v107, s63
    v_perm_b32 v154, v119, v115, s63
    v_perm_b32 v155, v127, v123, s63
    v_perm_b32 v156, v103, v99, s64
    v_perm_b32 v157, v111, v107, s64
    v_perm_b32 v158, v119, v115, s64
    v_perm_b32 v159, v127, v123, s64
    s_mov_b32 s88, 200000
    s_nop 0
    s_branch L_mc120
L_mp120:
    buffer_load_dwordx4 v[24:27], v3, s[52:55], s71 offen offset:0 sc1
    buffer_load_dwordx4 v[28:31], v3, s[52:55], s71 offen offset:1024 sc1
L_mc120:
    s_waitcnt vmcnt(0)
    v_xor_b32 v24, s61, v24
    v_xor_b32 v25, s61, v25
    v_xor_b32 v26, s61, v26
    v_xor_b32 v27, s61, v27
    v_xor_b32 v28, s61, v28
    v_xor_b32 v29, s61, v29
    v_xor_b32 v30, s61, v30
    v_xor_b32 v31, s61, v31
    v_or3_b32 v16, v24, v25, v26
    v_or3_b32 v16, v16, v27, v28
    v_or3_b32 v16, v16, v29, v30
    v_or_b32 v16, v16, v31
    v_and_b32 v16, 0xfff, v16
    v_cmp_ne_u32 vcc, 0, v16
    s_nop 0
    s_and_b64 exec, exec, vcc
    s_cbranch_scc0 L_mok120
    s_bcnt1_i32_b64 s59, exec
    s_cmp_lt_u32 s59, 32
    s_cbranch_scc1 L_mn120
    s_sleep 8
L_mn120:
    s_sub_u32 s88, s88, 1
    s_cbranch_scc0 L_mp120
L_mok120:
    s_mov_b64 exec, -1
    v_mul_f32 v24, v44, v24
    v_mul_f32 v25, v44, v25
    v_mul_f32 v26, v44, v26
    v_mul_f32 v27, v44, v27
    v_fmac_f32 v24, v45, v28
    v_fmac_f32 v25, v45, v29
    v_fmac_f32 v26, v45, v30
    v_fmac_f32 v27, v45, v31
    s_nop 0
    v_permlane32_swap_b32 v24, v26
    v_permlane32_swap_b32 v25, v27
    v_pk_add_f32 v[24:25], v[24:25], v[26:27]
    s_nop 1
    v_permlane16_swap_b32 v24, v25
    v_add_f32 v24, v24, v25
    s_nop 1
    v_add_f32_dpp v24, v24, v24 row_ror:8 row_mask:0xf bank_mask:0xf
    ds_write_b32 v18, v24 offset:4608
    v_mov_b32 v21, 16
    v_mov_b32 v22, 1
    s_mov_b64 exec, 1
    ds_add_u32 v21, v22
    s_mov_b64 exec, -1
    v_mov_b32 v21, 0
    s_mov_b32 s88, 1600000
    s_nop 0
L_sw121:
    ds_read_b32 v22, v21 offset:16
    s_waitcnt lgkmcnt(0)
    v_readfirstlane_b32 s59, v22
    s_nop 0
    s_cmp_ge_u32 s59, 4
    s_cbranch_scc1 L_swok121
    s_sub_u32 s88, s88, 1
    s_cbranch_scc0 L_sw121
L_swok121:
    ds_read_b128 v[24:27], v19 offset:4608
    ds_read_b128 v[28:31], v19 offset:4736
    ds_read_b128 v[32:35], v19 offset:4624
    ds_read_b128 v[36:39], v19 offset:4752
    s_waitcnt lgkmcnt(2)
    v_pk_add_f32 v[24:25], v[24:25], v[28:29]
    v_pk_add_f32 v[26:27], v[26:27], v[30:31]
    v_cvt_pk_bf16_f32 v16, v24, v25
    v_cvt_pk_bf16_f32 v17, v26, v27
    s_waitcnt lgkmcnt(0)
    v_pk_add_f32 v[32:33], v[32:33], v[36:37]
    v_pk_add_f32 v[34:35], v[34:35], v[38:39]
    v_cvt_pk_bf16_f32 v18, v32, v33
    v_cvt_pk_bf16_f32 v19, v34, v35
    v_cndmask_b32 v64, 0, v16, s[72:73]
    v_cndmask_b32 v65, 0, v17, s[72:73]
    v_cndmask_b32 v66, 0, v18, s[72:73]
    v_cndmask_b32 v67, 0, v19, s[72:73]
    v_cndmask_b32 v68, 0, v16, s[74:75]
    v_cndmask_b32 v69, 0, v17, s[74:75]
    v_cndmask_b32 v70, 0, v18, s[74:75]
    v_cndmask_b32 v71, 0, v19, s[74:75]
    v_mfma_f32_16x16x32_bf16 v[48:51], v[64:67], v[128:131], 0
    v_cndmask_b32 v72, 0, v16, s[76:77]
    v_cndmask_b32 v73, 0, v17, s[76:77]
    v_cndmask_b32 v74, 0, v18, s[76:77]
    v_cndmask_b32 v75, 0, v19, s[76:77]
    v_mfma_f32_16x16x32_bf16 v[48:51], v[68:71], v[132:135], v[48:51]
    v_cndmask_b32 v76, 0, v16, s[78:79]
    v_cndmask_b32 v77, 0, v17, s[78:79]
    v_cndmask_b32 v78, 0, v18, s[78:79]
    v_cndmask_b32 v79, 0, v19, s[78:79]
    v_mfma_f32_16x16x32_bf16 v[48:51], v[72:75], v[136:139], v[48:51]
    v_cndmask_b32 v80, 0, v16, s[80:81]
    v_cndmask_b32 v81, 0, v17, s[80:81]
    v_cndmask_b32 v82, 0, v18, s[80:81]
    v_cndmask_b32 v83, 0, v19, s[80:81]
    v_mfma_f32_16x16x32_bf16 v[48:51], v[76:79], v[140:143], v[48:51]
    v_cndmask_b32 v84, 0, v16, s[82:83]
    v_cndmask_b32 v85, 0, v17, s[82:83]
    v_cndmask_b32 v86, 0, v18, s[82:83]
    v_cndmask_b32 v87, 0, v19, s[82:83]
    v_mfma_f32_16x16x32_bf16 v[48:51], v[80:83], v[144:147], v[48:51]
    v_cndmask_b32 v88, 0, v16, s[84:85]
    v_cndmask_b32 v89, 0, v17, s[84:85]
    v_cndmask_b32 v90, 0, v18, s[84:85]
    v_cndmask_b32 v91, 0, v19, s[84:85]
    v_mfma_f32_16x16x32_bf16 v[48:51], v[84:87], v[148:151], v[48:51]
    v_cndmask_b32 v92, 0, v16, s[86:87]
    v_cndmask_b32 v93, 0, v17, s[86:87]
    v_cndmask_b32 v94, 0, v18, s[86:87]
    v_cndmask_b32 v95, 0, v19, s[86:87]
    v_mfma_f32_16x16x32_bf16 v[48:51], v[88:91], v[152:155], v[48:51]
    s_nop 0
    v_mfma_f32_16x16x32_bf16 v[48:51], v[92:95], v[156:159], v[48:51]
    s_nop 7
    v_add_u32 v48, 0x800, v48
    v_add_u32 v49, 0x800, v49
    v_add_u32 v50, 0x800, v50
    v_add_u32 v51, 0x800, v51
    v_mov_b32 v21, s61
    v_and_or_b32 v48, v48, s67, v21
    v_and_or_b32 v49, v49, s67, v21
    v_and_or_b32 v50, v50, s67, v21
    v_and_or_b32 v51, v51, s67, v21
    buffer_store_dwordx4 v[48:51], v15, s[52:55], s91 offen sc1
L_fin:
L_end:
    s_endpgm
.section .rodata,"a"
.p2align 6
.amdhsa_kernel parallel_sum__gqa_block_cached__dense_activation_silu__decode_kernel
  .amdhsa_next_free_vgpr 168
  .amdhsa_next_free_sgpr 102
  .amdhsa_accum_offset 168
  .amdhsa_group_segment_fixed_size 0
  .amdhsa_kernarg_size 88
  .amdhsa_user_sgpr_count 2
  .amdhsa_user_sgpr_kernarg_segment_ptr 1
  .amdhsa_system_sgpr_workgroup_id_x 1
.end_amdhsa_kernel
```
